```python
import torch

def _softmax(x, axis=-1):
    return torch.softmax(x, dim=axis)
def _gelu(x):
    return torch.nn.functional.gelu(x, approximate="tanh")
def _silu(x):
    return torch.nn.functional.silu(x)
def _sigmoid(x):
    return torch.sigmoid(x)
def _layernorm(x, axis=-1, eps=1e-5):
    m = x.mean(dim=axis, keepdim=True)
    v = x.var(dim=axis, keepdim=True, unbiased=False)
    return (x - m) / torch.sqrt(v + eps)
def _scatter_add(tgt, idx, src, axis=0):
    return tgt.clone().index_add_(axis, idx, src)
def _segment_sum(src, seg, n):
    out = torch.zeros((n,) + src.shape[1:], dtype=src.dtype)
    return out.index_add_(0, seg, src)
def _pad(x, pw):
    flat = tuple(v for pair in reversed(pw) for v in pair)
    return torch.nn.functional.pad(x, flat)

kernel_name = 'recurrent_scan__mha_block__glu_gated_glu__prompt'

def setup_inputs():

    _w = (lambda a: (lambda t: t.to(torch.bfloat16) if t.is_floating_point() else t)(torch.as_tensor(a)))
    def _A_setup():
        B, S, D, H = 1, 2048, 512, 32
        return {
            "x": _w((lambda *s: torch.randn(*s, dtype=torch.bfloat16) * 0.05)(B, S, D)),
            "wqkv": _w((lambda *s: torch.randn(*s, dtype=torch.bfloat16) * 0.05)(D, 3 * D)),
            "wo": _w((lambda *s: torch.randn(*s, dtype=torch.bfloat16) * 0.05)(D, D)),
        }
    _A_in = _A_setup()

    def _B_setup():
        B, S, D, F = 1, 2048, 512, 1792
        return {
            "x": _w((lambda *s: torch.randn(*s, dtype=torch.bfloat16) * 0.05)(B, S, D)),
            "w_gate": _w((lambda *s: torch.randn(*s, dtype=torch.bfloat16) * 0.05)(D, F)),
            "w_up": _w((lambda *s: torch.randn(*s, dtype=torch.bfloat16) * 0.05)(D, F)),
            "w_down": _w((lambda *s: torch.randn(*s, dtype=torch.bfloat16) * 0.05)(F, D)),
        }
    _B_in = _B_setup()

    return {
        "A_x": _A_in["x"],
        "A_wqkv": _A_in["wqkv"],
        "A_wo": _A_in["wo"],
        "B_x": _B_in["x"],
        "B_w_gate": _B_in["w_gate"],
        "B_w_up": _B_in["w_up"],
        "B_w_down": _B_in["w_down"],
    }

def reference(A_x, A_wqkv, A_wo, B_x, B_w_gate, B_w_up, B_w_down):
    def _A_ref(x, wqkv, wo):
        B, S, D = x.shape
        H = 32
        Dh = D // H
        qkv = (lambda x, *d: x.permute(*d))((x @ wqkv).reshape(B, S, 3, H, Dh), 2, 0, 3, 1, 4)
        q, k, v = qkv[0], qkv[1], qkv[2]
        scores = torch.einsum("bhqd,bhkd->bhqk", q, k) * (Dh ** -0.5)
        p = _softmax(scores, axis=-1)
        o = torch.einsum("bhqk,bhkd->bhqd", p, v)
        return (lambda x, *d: x.permute(*d))(o, 0, 2, 1, 3).reshape(B, S, D) @ wo

    def _B_ref(x, w_gate, w_up, w_down):
        g = torch.einsum("bsd,df->bsf", x, w_gate)
        u = torch.einsum("bsd,df->bsf", x, w_up)
        h = _sigmoid(g) * u
        return torch.einsum("bsf,fd->bsd", h, w_down)

    x = A_x
    xn = _layernorm(x, axis=-1)
    s = _A_ref(xn, A_wqkv, A_wo)
    g = _silu(_B_ref(xn, B_w_gate, B_w_up, B_w_down))
    return x + s * g
```

```asm
; @launch grid=(256,1,1) block=(768,1,1) lds=163840
.amdgcn_target "amdgcn-amd-amdhsa--gfx950"
.text
.globl recurrent_scan__mha_block__glu_gated_glu__prompt_kernel
.p2align 8
.type recurrent_scan__mha_block__glu_gated_glu__prompt_kernel,@function
recurrent_scan__mha_block__glu_gated_glu__prompt_kernel:
    s_cmp_ge_u32 s2, 256
    s_cbranch_scc1 F_end
    s_load_dwordx4 s[4:7], s[0:1], 0
    s_load_dwordx2 s[42:43], s[0:1], 16
    s_load_dwordx4 s[48:51], s[0:1], 32
    s_load_dwordx2 s[46:47], s[0:1], 48
    s_load_dwordx2 s[44:45], s[0:1], 56
    s_load_dwordx2 s[18:19], s[0:1], 64
    s_load_dwordx2 s[16:17], s[0:1], 72
    v_lshrrev_b32 v1, 6, v0
    v_and_b32 v0, 63, v0
    s_nop 0
    v_readfirstlane_b32 s3, v1
    s_cmp_lt_u32 s3, 8
    s_cbranch_scc0 F_lb
    s_bfe_u32 s24, s2, 0x20001
    s_lshl_b32 s24, s24, 2
    s_lshr_b32 s25, s2, 6
    s_add_u32 s24, s24, s25
    s_and_b32 s25, s2, 1
    s_lshl_b32 s25, s25, 3
    s_bfe_u32 s26, s2, 0x30003
    s_add_u32 s25, s25, s26
    v_lshlrev_b32 v2, 4, v0
    v_mov_b32 v118, 0
    v_mov_b32 v119, 1
    s_lshl_b32 s30, s24, 7
    s_lshl_b32 s28, s25, 3
    s_add_u32 s30, s30, s28
    s_add_u32 s31, s30, s3
    s_lshl_b32 s31, s31, 10
    s_waitcnt lgkmcnt(0)
    s_mov_b32 s8, s4
    s_mov_b32 s9, s5
    s_mov_b32 s10, 2097152
    s_mov_b32 s11, 0x00020000
    s_mov_b32 s20, s16
    s_mov_b32 s21, s17
    s_mov_b32 s22, 33554432
    s_mov_b32 s23, 0x00020000
    s_mov_b32 s52, s18
    s_mov_b32 s53, s19
    s_mov_b32 s54, 256
    s_mov_b32 s55, 0x00020000
    buffer_load_dwordx4 v[164:167], v2, s[8:11], s31 offen
    s_or_b32 s28, s2, s3
    s_cmp_eq_u32 s28, 0
    s_cbranch_scc0 F_nz
    s_memrealtime s[68:69]
    s_waitcnt lgkmcnt(0)
    s_or_b32 s68, s68, 1
    v_mov_b32 v24, s68
    v_mov_b32 v25, s69
    s_mov_b64 exec, 1
    buffer_store_dwordx2 v[24:25], v118, s[52:55], 0 offen sc1
    s_mov_b64 exec, -1
F_nz:
    s_barrier
    s_mul_i32 s28, s3, 1040
    s_add_u32 s28, s28, 149248
    v_add_u32 v140, s28, v2
    v_and_b32 v141, 7, v0
    v_mul_u32_u24 v142, 1040, v141
    v_lshrrev_b32 v143, 3, v0
    s_lshl_b32 s28, s3, 3
    v_add_u32 v143, s28, v143
    v_lshl_add_u32 v142, v143, 4, v142
    v_add_u32 v142, 149248, v142
    v_lshlrev_b32 v143, 9, v143
    v_lshl_add_u32 v143, v141, 4, v143
    s_lshr_b32 s28, s30, 5
    s_lshl_b32 s28, s28, 15
    s_and_b32 s29, s30, 31
    s_lshl_b32 s29, s29, 4
    s_add_u32 s28, s28, s29
    s_add_u32 s28, s28, 25165824
    s_cmp_eq_u32 s3, 7
    s_cselect_b32 s57, 5, 0
    s_lshl_b32 s59, s24, 4
    s_add_u32 s59, s59, s25
    s_lshl_b32 s59, s59, 7
    s_add_u32 s59, s59, 31457280
    s_lshl_b32 s60, s24, 11
    s_add_u32 s60, s60, 31457280
    v_and_b32 v138, 15, v0
    v_lshlrev_b32 v138, 7, v138
    s_lshl_b32 s61, s24, 10
    s_and_b32 s62, s3, 3
    s_lshl_b32 s62, s62, 8
    s_add_u32 s61, s61, s62
    s_add_u32 s61, s61, 30408704
    v_and_b32 v23, 31, v0
    v_lshlrev_b32 v23, 3, v23
    s_mov_b32 s62, 0
    s_and_b32 s26, s3, 3
    v_and_b32 v4, 31, v0
    v_lshrrev_b32 v5, 5, v0
    v_bfe_u32 v6, v0, 1, 3
    v_xor_b32 v6, v5, v6
    s_lshl_b32 s34, s26, 12
    s_add_u32 s34, s34, 768
    v_lshlrev_b32 v4, 7, v4
    v_add_u32 v4, s34, v4
    v_xor_b32 v7, 0, v6
    v_lshl_add_u32 v11, v7, 4, v4
    v_xor_b32 v7, 2, v6
    v_lshl_add_u32 v12, v7, 4, v4
    v_xor_b32 v7, 4, v6
    v_lshl_add_u32 v13, v7, 4, v4
    v_xor_b32 v7, 6, v6
    v_lshl_add_u32 v14, v7, 4, v4
    v_bfe_u32 v6, v0, 2, 2
    v_lshl_add_u32 v6, v5, 3, v6
    v_lshlrev_b32 v6, 6, v6
    v_bfe_u32 v7, v0, 4, 1
    v_lshl_add_u32 v6, v7, 5, v6
    v_and_b32 v7, 3, v0
    v_lshl_add_u32 v6, v7, 3, v6
    v_add_u32 v15, 17152, v6
    v_mov_b32 v32, 0
    v_mov_b32 v33, 0
    v_mov_b32 v34, 0
    v_mov_b32 v35, 0
    v_mov_b32 v36, 0
    v_mov_b32 v37, 0
    v_mov_b32 v38, 0
    v_mov_b32 v39, 0
    v_mov_b32 v40, 0
    v_mov_b32 v41, 0
    v_mov_b32 v42, 0
    v_mov_b32 v43, 0
    v_mov_b32 v44, 0
    v_mov_b32 v45, 0
    v_mov_b32 v46, 0
    v_mov_b32 v47, 0
    v_mov_b32 v48, 0
    v_mov_b32 v49, 0
    v_mov_b32 v50, 0
    v_mov_b32 v51, 0
    v_mov_b32 v52, 0
    v_mov_b32 v53, 0
    v_mov_b32 v54, 0
    v_mov_b32 v55, 0
    v_mov_b32 v56, 0
    v_mov_b32 v57, 0
    v_mov_b32 v58, 0
    v_mov_b32 v59, 0
    v_mov_b32 v60, 0
    v_mov_b32 v61, 0
    v_mov_b32 v62, 0
    v_mov_b32 v63, 0
    v_mov_b32 v120, 0
    v_mov_b32 v121, 0
    v_mov_b32 v122, 0
    v_mov_b32 v123, 0
    v_mov_b32 v124, 0
    v_mov_b32 v125, 0
    v_mov_b32 v126, 0
    v_mov_b32 v127, 0
    v_and_b32 v6, 15, v0
    v_bfe_u32 v7, v0, 4, 1
    v_cmp_eq_u32 vcc, v6, v7
    v_mov_b32 v6, 0x3f803f80
    s_nop 0
    v_cndmask_b32 v112, 0, v6, vcc
    v_mov_b32 v113, v112
    v_mov_b32 v114, v112
    v_mov_b32 v115, v112
    s_mov_b32 s36, 57344
    s_mov_b32 s39, 8
    s_or_b32 s29, s2, s3
    s_cmp_eq_u32 s29, 0
    s_cbranch_scc1 F_w0
    s_waitcnt vmcnt(0)
F_w0:
    s_waitcnt vmcnt(1)
    v_lshlrev_b32 v144, 16, v164
    v_and_b32 v145, 0xffff0000, v164
    v_lshlrev_b32 v146, 16, v165
    v_and_b32 v147, 0xffff0000, v165
    v_lshlrev_b32 v148, 16, v166
    v_and_b32 v149, 0xffff0000, v166
    v_lshlrev_b32 v150, 16, v167
    v_and_b32 v151, 0xffff0000, v167
    v_add_f32 v160, v144, v145
    v_mul_f32 v161, v144, v144
    v_fmac_f32 v161, v145, v145
    v_add_f32 v160, v160, v146
    v_fmac_f32 v161, v146, v146
    v_add_f32 v160, v160, v147
    v_fmac_f32 v161, v147, v147
    v_add_f32 v160, v160, v148
    v_fmac_f32 v161, v148, v148
    v_add_f32 v160, v160, v149
    v_fmac_f32 v161, v149, v149
    v_add_f32 v160, v160, v150
    v_fmac_f32 v161, v150, v150
    v_add_f32 v160, v160, v151
    v_fmac_f32 v161, v151, v151
    s_nop 0
    v_add_f32_dpp v160, v160, v160 quad_perm:[1,0,3,2] row_mask:0xf bank_mask:0xf
    v_add_f32_dpp v161, v161, v161 quad_perm:[1,0,3,2] row_mask:0xf bank_mask:0xf
    s_nop 0
    v_add_f32_dpp v160, v160, v160 quad_perm:[2,3,0,1] row_mask:0xf bank_mask:0xf
    v_add_f32_dpp v161, v161, v161 quad_perm:[2,3,0,1] row_mask:0xf bank_mask:0xf
    s_nop 0
    v_add_f32_dpp v160, v160, v160 row_half_mirror row_mask:0xf bank_mask:0xf
    v_add_f32_dpp v161, v161, v161 row_half_mirror row_mask:0xf bank_mask:0xf
    s_nop 0
    v_add_f32_dpp v160, v160, v160 row_mirror row_mask:0xf bank_mask:0xf
    v_add_f32_dpp v161, v161, v161 row_mirror row_mask:0xf bank_mask:0xf
    s_nop 0
    v_mov_b32 v162, v160
    v_mov_b32 v163, v161
    s_nop 0
    v_permlane16_swap_b32 v162, v160
    v_permlane16_swap_b32 v163, v161
    s_nop 0
    v_add_f32 v160, v160, v162
    v_add_f32 v161, v161, v163
    v_mov_b32 v162, v160
    v_mov_b32 v163, v161
    s_nop 0
    v_permlane32_swap_b32 v162, v160
    v_permlane32_swap_b32 v163, v161
    s_nop 0
    v_add_f32 v160, v160, v162
    v_add_f32 v161, v161, v163
    v_mul_f32 v160, 0x3b000000, v160
    v_mul_f32 v161, 0x3b000000, v161
    v_fma_f32 v161, -v160, v160, v161
    v_cvt_pk_bf16_f32 v160, v160, v160
    v_and_b32 v160, 0xffff0000, v160
    v_max_f32 v161, 0, v161
    v_cvt_pk_bf16_f32 v161, v161, v161
    v_and_b32 v161, 0xffff0000, v161
    v_add_f32 v161, 0x3727c5ac, v161
    v_cvt_pk_bf16_f32 v161, v161, v161
    v_and_b32 v161, 0xffff0000, v161
    v_sqrt_f32 v161, v161
    s_nop 0
    v_cvt_pk_bf16_f32 v161, v161, v161
    v_and_b32 v161, 0xffff0000, v161
    v_rcp_f32 v161, v161
    s_nop 0
    s_lshr_b32 s29, s31, 7
    s_add_u32 s29, s29, 30408704
    s_mov_b64 exec, 1
    buffer_store_dwordx2 v[160:161], v118, s[20:23], s29 offen sc1
    s_mov_b64 exec, -1
    v_sub_f32 v144, v144, v160
    v_sub_f32 v145, v145, v160
    v_sub_f32 v146, v146, v160
    v_sub_f32 v147, v147, v160
    v_sub_f32 v148, v148, v160
    v_sub_f32 v149, v149, v160
    v_sub_f32 v150, v150, v160
    v_sub_f32 v151, v151, v160
    v_cvt_pk_bf16_f32 v164, v144, v145
    v_cvt_pk_bf16_f32 v165, v146, v147
    v_cvt_pk_bf16_f32 v166, v148, v149
    v_cvt_pk_bf16_f32 v167, v150, v151
    v_lshlrev_b32 v144, 16, v164
    v_and_b32 v145, 0xffff0000, v164
    v_lshlrev_b32 v146, 16, v165
    v_and_b32 v147, 0xffff0000, v165
    v_lshlrev_b32 v148, 16, v166
    v_and_b32 v149, 0xffff0000, v166
    v_lshlrev_b32 v150, 16, v167
    v_and_b32 v151, 0xffff0000, v167
    v_mul_f32 v144, v144, v161
    v_mul_f32 v145, v145, v161
    v_mul_f32 v146, v146, v161
    v_mul_f32 v147, v147, v161
    v_mul_f32 v148, v148, v161
    v_mul_f32 v149, v149, v161
    v_mul_f32 v150, v150, v161
    v_mul_f32 v151, v151, v161
    v_cvt_pk_bf16_f32 v164, v144, v145
    v_cvt_pk_bf16_f32 v165, v146, v147
    v_cvt_pk_bf16_f32 v166, v148, v149
    v_cvt_pk_bf16_f32 v167, v150, v151
    ds_write_b128 v140, v[164:167]
    s_waitcnt lgkmcnt(0)
    s_mov_b64 exec, 1
    ds_add_u32 v118, v119 offset:0
    s_mov_b64 exec, -1
Lw1:
    ds_read_b32 v139, v118 offset:0
    s_waitcnt lgkmcnt(0)
    v_readfirstlane_b32 s29, v139
    s_cmp_ge_u32 s29, 8
    s_cbranch_scc1 Lw1x
    s_branch Lw1
Lw1x:
    ds_read_b128 v[164:167], v142
    s_waitcnt lgkmcnt(0)
    buffer_store_dwordx4 v[164:167], v143, s[20:23], s28 offen sc1
    buffer_load_dwordx2 v[116:117], v118, s[52:55], 0 offen sc1
    s_cmp_lt_u32 s3, 4
    s_cbranch_scc0 F_kv
    s_setprio 2
    v_add_u32 v16, s36, v11
    v_add_u32 v17, s36, v12
    v_add_u32 v18, s36, v13
    v_add_u32 v19, s36, v14
    v_add_u32 v20, s36, v15
    s_add_u32 s36, s36, 28672
    s_cmp_eq_u32 s36, 143360
    s_cselect_b32 s36, 0, s36
    s_barrier
    ds_read_b128 v[64:67], v16
    ds_read_b64_tr_b16 v[80:81], v20 offset:0
    ds_read_b64_tr_b16 v[82:83], v20 offset:256
    ds_read_b64_tr_b16 v[84:85], v20 offset:4096
    ds_read_b64_tr_b16 v[86:87], v20 offset:4352
    ds_read_b128 v[68:71], v17
    ds_read_b64_tr_b16 v[88:89], v20 offset:1024
    ds_read_b64_tr_b16 v[90:91], v20 offset:1280
    ds_read_b64_tr_b16 v[92:93], v20 offset:5120
    ds_read_b64_tr_b16 v[94:95], v20 offset:5376
    ds_read_b128 v[72:75], v18
    ds_read_b64_tr_b16 v[96:97], v20 offset:2048
    ds_read_b64_tr_b16 v[98:99], v20 offset:2304
    ds_read_b64_tr_b16 v[100:101], v20 offset:6144
    ds_read_b64_tr_b16 v[102:103], v20 offset:6400
    s_waitcnt lgkmcnt(9)
    ds_read_b128 v[76:79], v19
    ds_read_b64_tr_b16 v[104:105], v20 offset:3072
    ds_read_b64_tr_b16 v[106:107], v20 offset:3328
    ds_read_b64_tr_b16 v[108:109], v20 offset:7168
    ds_read_b64_tr_b16 v[110:111], v20 offset:7424
F_c0_loop:
    v_mfma_f32_32x32x16_bf16 v[32:47], v[80:83], v[64:67], v[32:47]
    v_mfma_f32_32x32x16_bf16 v[48:63], v[84:87], v[64:67], v[48:63]
    s_waitcnt lgkmcnt(12)
    v_mfma_f32_32x32x16_bf16 v[32:47], v[88:91], v[68:71], v[32:47]
    s_waitcnt lgkmcnt(10)
    v_mfma_f32_32x32x16_bf16 v[48:63], v[92:95], v[68:71], v[48:63]
    s_cmp_eq_u32 s26, 0
    s_cbranch_scc0 F_c0_nocs0_0
    v_mfma_f32_16x16x32_bf16 v[120:123], v[112:115], v[80:83], v[120:123]
    v_mfma_f32_16x16x32_bf16 v[120:123], v[112:115], v[88:91], v[120:123]
F_c0_nocs0_0:
    s_cmp_eq_u32 s26, 1
    s_cbranch_scc0 F_c0_nocs0_1
    v_mfma_f32_16x16x32_bf16 v[120:123], v[112:115], v[84:87], v[120:123]
    v_mfma_f32_16x16x32_bf16 v[120:123], v[112:115], v[92:95], v[120:123]
F_c0_nocs0_1:
    s_sub_u32 s39, s39, 1
    s_cmp_eq_u32 s39, 0
    s_cbranch_scc1 F_c0_last
    v_add_u32 v16, s36, v11
    v_add_u32 v17, s36, v12
    v_add_u32 v18, s36, v13
    v_add_u32 v19, s36, v14
    v_add_u32 v20, s36, v15
    s_add_u32 s36, s36, 28672
    s_cmp_eq_u32 s36, 143360
    s_cselect_b32 s36, 0, s36
    s_cmp_eq_u32 s39, 6
    s_cbranch_scc0 F_c0_noxf
    s_waitcnt vmcnt(0)
    v_readfirstlane_b32 s68, v116
    v_readfirstlane_b32 s69, v117
    s_cmp_eq_u32 s68, 0
    s_cbranch_scc0 F_c0_hn
Lr2:
    buffer_load_dwordx2 v[128:129], v118, s[52:55], 0 offen sc1
    s_waitcnt vmcnt(0)
    v_readfirstlane_b32 s68, v128
    v_readfirstlane_b32 s69, v129
    s_cmp_eq_u32 s68, 0
    s_cbranch_scc1 Lr2
F_c0_hn:
    s_mov_b64 exec, 1
    ds_add_rtn_u32 v128, v118, v119 offset:4
    s_waitcnt lgkmcnt(0)
    v_readfirstlane_b32 s29, v128
    s_cmp_eq_u32 s29, 7
    s_cbranch_scc0 F_c0_px
    v_mov_b32 v128, s68
    v_mov_b32 v129, s69
    buffer_store_dwordx2 v[128:129], v118, s[20:23], s59 offen sc1
F_c0_px:
    s_mov_b64 exec, -1
F_c0_noxf:
    s_cmp_gt_u32 s39, 3
    s_cbranch_scc1 F_c0_stx
    s_cmp_eq_u32 s62, 1
    s_cbranch_scc1 F_c0_stx
    s_cmp_eq_u32 s62, 0
    s_cbranch_scc1 F_c0_sti
    s_waitcnt vmcnt(0)
    v_cmp_ne_u64 vcc, s[68:69], v[130:131]
    s_nop 1
    s_cmp_eq_u64 vcc, 0
    s_cbranch_scc0 F_c0_sti
    buffer_load_dwordx2 v[124:125], v23, s[20:23], s61 offen sc1
    s_mov_b32 s62, 1
    s_branch F_c0_stx
F_c0_sti:
    buffer_load_dwordx2 v[130:131], v138, s[20:23], s60 offen sc1
    s_mov_b32 s62, 2
F_c0_stx:
    s_waitcnt lgkmcnt(0)
    s_barrier
    ds_read_b128 v[64:67], v16
    ds_read_b64_tr_b16 v[80:81], v20 offset:0
    ds_read_b64_tr_b16 v[82:83], v20 offset:256
    ds_read_b64_tr_b16 v[84:85], v20 offset:4096
    ds_read_b64_tr_b16 v[86:87], v20 offset:4352
    ds_read_b128 v[68:71], v17
    ds_read_b64_tr_b16 v[88:89], v20 offset:1024
    ds_read_b64_tr_b16 v[90:91], v20 offset:1280
    ds_read_b64_tr_b16 v[92:93], v20 offset:5120
    ds_read_b64_tr_b16 v[94:95], v20 offset:5376
    v_mfma_f32_32x32x16_bf16 v[32:47], v[96:99], v[72:75], v[32:47]
    v_mfma_f32_32x32x16_bf16 v[48:63], v[100:103], v[72:75], v[48:63]
    v_mfma_f32_32x32x16_bf16 v[32:47], v[104:107], v[76:79], v[32:47]
    v_mfma_f32_32x32x16_bf16 v[48:63], v[108:111], v[76:79], v[48:63]
    s_cmp_eq_u32 s26, 0
    s_cbranch_scc0 F_c0_nocs1_0
    v_mfma_f32_16x16x32_bf16 v[120:123], v[112:115], v[96:99], v[120:123]
    v_mfma_f32_16x16x32_bf16 v[120:123], v[112:115], v[104:107], v[120:123]
F_c0_nocs1_0:
    s_cmp_eq_u32 s26, 1
    s_cbranch_scc0 F_c0_nocs1_1
    v_mfma_f32_16x16x32_bf16 v[120:123], v[112:115], v[100:103], v[120:123]
    v_mfma_f32_16x16x32_bf16 v[120:123], v[112:115], v[108:111], v[120:123]
F_c0_nocs1_1:
    ds_read_b128 v[72:75], v18
    ds_read_b64_tr_b16 v[96:97], v20 offset:2048
    ds_read_b64_tr_b16 v[98:99], v20 offset:2304
    ds_read_b64_tr_b16 v[100:101], v20 offset:6144
    ds_read_b64_tr_b16 v[102:103], v20 offset:6400
    s_waitcnt lgkmcnt(9)
    ds_read_b128 v[76:79], v19
    ds_read_b64_tr_b16 v[104:105], v20 offset:3072
    ds_read_b64_tr_b16 v[106:107], v20 offset:3328
    ds_read_b64_tr_b16 v[108:109], v20 offset:7168
    ds_read_b64_tr_b16 v[110:111], v20 offset:7424
    s_branch F_c0_loop
F_c0_last:
    s_waitcnt lgkmcnt(0)
    v_mfma_f32_32x32x16_bf16 v[32:47], v[96:99], v[72:75], v[32:47]
    v_mfma_f32_32x32x16_bf16 v[48:63], v[100:103], v[72:75], v[48:63]
    v_mfma_f32_32x32x16_bf16 v[32:47], v[104:107], v[76:79], v[32:47]
    v_mfma_f32_32x32x16_bf16 v[48:63], v[108:111], v[76:79], v[48:63]
    s_cmp_eq_u32 s26, 0
    s_cbranch_scc0 F_c0x_nocs1_0
    v_mfma_f32_16x16x32_bf16 v[120:123], v[112:115], v[96:99], v[120:123]
    v_mfma_f32_16x16x32_bf16 v[120:123], v[112:115], v[104:107], v[120:123]
F_c0x_nocs1_0:
    s_cmp_eq_u32 s26, 1
    s_cbranch_scc0 F_c0x_nocs1_1
    v_mfma_f32_16x16x32_bf16 v[120:123], v[112:115], v[100:103], v[120:123]
    v_mfma_f32_16x16x32_bf16 v[120:123], v[112:115], v[108:111], v[120:123]
F_c0x_nocs1_1:
    s_cmp_eq_u32 s62, 1
    s_cbranch_scc1 F_c0x_sux
    s_cmp_eq_u32 s62, 0
    s_cbranch_scc1 F_c0x_sui
    s_waitcnt vmcnt(0)
    v_cmp_ne_u64 vcc, s[68:69], v[130:131]
    s_nop 1
    s_cmp_eq_u64 vcc, 0
    s_cbranch_scc0 F_c0x_sui
    buffer_load_dwordx2 v[124:125], v23, s[20:23], s61 offen sc1
    s_mov_b32 s62, 1
    s_branch F_c0x_sux
F_c0x_sui:
    buffer_load_dwordx2 v[130:131], v138, s[20:23], s60 offen sc1
    s_mov_b32 s62, 2
F_c0x_sux:
    v_lshlrev_b32 v4, 2, v0
    v_cmp_gt_u32 vcc, 16, v0
    s_lshl_b32 s34, s26, 7
    s_cmp_lt_u32 s26, 2
    s_cselect_b32 s34, s34, 512
    v_mov_b32 v5, 512
    v_mov_b32 v6, s34
    v_cndmask_b32 v5, v5, v6, vcc
    v_add_u32 v5, v5, v4
    v_add_u32 v5, 144128, v5
    s_nop 1
    ds_write_b32 v5, v120
    ds_write_b32 v5, v121 offset:64
    v_and_b32 v6, 31, v0
    s_lshl_b32 s34, s26, 8
    s_add_u32 s34, s34, 145152
    v_lshl_add_u32 v7, v6, 3, s34
    v_lshlrev_b32 v6, 2, v6
    v_lshrrev_b32 v8, 5, v0
    v_lshlrev_b32 v8, 4, v8
    s_lshl_b32 s37, s25, 7
    s_lshl_b32 s35, s24, 2
    s_add_u32 s37, s37, s35
    s_add_u32 s37, s37, s26
    s_waitcnt lgkmcnt(0)
    s_mov_b64 exec, 1
    ds_add_u32 v118, v119 offset:12
    s_mov_b64 exec, -1
Lw3:
    ds_read_b32 v9, v118 offset:12
    s_waitcnt lgkmcnt(0)
    v_readfirstlane_b32 s29, v9
    s_cmp_ge_u32 s29, 8
    s_cbranch_scc1 Lw3x
    s_branch Lw3
Lw3x:
    v_add_u32 v8, 144128, v8
    ds_read_b128 v[80:83], v8 offset:0
    ds_read_b128 v[84:87], v8 offset:32
    ds_read_b128 v[88:91], v8 offset:64
    ds_read_b128 v[92:95], v8 offset:96
    ds_read_b128 v[96:99], v8 offset:128
    ds_read_b128 v[100:103], v8 offset:160
    ds_read_b128 v[104:107], v8 offset:192
    ds_read_b128 v[108:111], v8 offset:224
    s_cmp_eq_u32 s62, 1
    s_cbranch_scc1 F_c0x_svx
    s_cmp_eq_u32 s62, 0
    s_cbranch_scc1 F_c0x_svi
    s_waitcnt vmcnt(0)
    v_cmp_ne_u64 vcc, s[68:69], v[130:131]
    s_nop 1
    s_cmp_eq_u64 vcc, 0
    s_cbranch_scc0 F_c0x_svi
    buffer_load_dwordx2 v[124:125], v23, s[20:23], s61 offen sc1
    s_mov_b32 s62, 1
    s_branch F_c0x_svx
F_c0x_svi:
F_c0x_svx:
    s_cmp_eq_u32 s62, 1
    s_cbranch_scc1 F_c0x_sok
Lq4:
    buffer_load_dwordx2 v[128:129], v138, s[20:23], s60 offen sc1
    s_waitcnt vmcnt(0)
    v_cmp_ne_u64 vcc, s[68:69], v[128:129]
    s_nop 1
    s_cmp_eq_u64 vcc, 0
    s_cbranch_scc1 Lq4x
    s_branch Lq4
Lq4x:
    buffer_load_dwordx2 v[124:125], v23, s[20:23], s61 offen sc1
F_c0x_sok:
    s_waitcnt vmcnt(0)
    s_lshl_b32 s35, s37, 11
    s_add_u32 s36, s35, 2228224
    s_add_u32 s35, s35, 2097152
    v_mul_f32 v6, 0x3eb8aa3b, v125
    s_waitcnt lgkmcnt(0)
    v_fma_f32 v48, -v124, v96, v48
    v_mul_f32 v48, v48, v125
    v_fma_f32 v49, -v124, v97, v49
    v_mul_f32 v49, v49, v125
    v_fma_f32 v50, -v124, v98, v50
    v_mul_f32 v50, v50, v125
    v_fma_f32 v51, -v124, v99, v51
    v_mul_f32 v51, v51, v125
    v_fma_f32 v52, -v124, v100, v52
    v_mul_f32 v52, v52, v125
    v_fma_f32 v53, -v124, v101, v53
    v_mul_f32 v53, v53, v125
    v_fma_f32 v54, -v124, v102, v54
    v_mul_f32 v54, v54, v125
    v_fma_f32 v55, -v124, v103, v55
    v_mul_f32 v55, v55, v125
    v_fma_f32 v56, -v124, v104, v56
    v_mul_f32 v56, v56, v125
    v_fma_f32 v57, -v124, v105, v57
    v_mul_f32 v57, v57, v125
    v_fma_f32 v58, -v124, v106, v58
    v_mul_f32 v58, v58, v125
    v_fma_f32 v59, -v124, v107, v59
    v_mul_f32 v59, v59, v125
    v_fma_f32 v60, -v124, v108, v60
    v_mul_f32 v60, v60, v125
    v_fma_f32 v61, -v124, v109, v61
    v_mul_f32 v61, v61, v125
    v_fma_f32 v62, -v124, v110, v62
    v_mul_f32 v62, v62, v125
    v_fma_f32 v63, -v124, v111, v63
    v_mul_f32 v63, v63, v125
    v_cvt_pk_bf16_f32 v72, v48, v49
    v_cvt_pk_bf16_f32 v73, v50, v51
    v_cvt_pk_bf16_f32 v74, v52, v53
    v_cvt_pk_bf16_f32 v75, v54, v55
    v_cvt_pk_bf16_f32 v76, v56, v57
    v_cvt_pk_bf16_f32 v77, v58, v59
    v_cvt_pk_bf16_f32 v78, v60, v61
    v_cvt_pk_bf16_f32 v79, v62, v63
    buffer_store_dwordx4 v[72:75], v2, s[20:23], s35 offen sc1
    buffer_store_dwordx4 v[76:79], v2, s[20:23], s36 offen sc1
    s_lshl_b32 s35, s26, 11
    s_add_u32 s35, s35, 87040
    v_add_u32 v7, s35, v2
    ds_write_b128 v7, v[72:75]
    ds_write_b128 v7, v[76:79] offset:32768
    s_lshl_b32 s35, s26, 10
    s_add_u32 s35, s35, 152576
    v_add_u32 v7, s35, v2
    v_fma_f32 v32, -v124, v80, v32
    v_mul_f32 v32, v32, v6
    v_fma_f32 v33, -v124, v81, v33
    v_mul_f32 v33, v33, v6
    v_fma_f32 v34, -v124, v82, v34
    v_mul_f32 v34, v34, v6
    v_fma_f32 v35, -v124, v83, v35
    v_mul_f32 v35, v35, v6
    v_fma_f32 v36, -v124, v84, v36
    v_mul_f32 v36, v36, v6
    v_fma_f32 v37, -v124, v85, v37
    v_mul_f32 v37, v37, v6
    v_fma_f32 v38, -v124, v86, v38
    v_mul_f32 v38, v38, v6
    v_fma_f32 v39, -v124, v87, v39
    v_mul_f32 v39, v39, v6
    v_fma_f32 v40, -v124, v88, v40
    v_mul_f32 v40, v40, v6
    v_fma_f32 v41, -v124, v89, v41
    v_mul_f32 v41, v41, v6
    v_fma_f32 v42, -v124, v90, v42
    v_mul_f32 v42, v42, v6
    v_fma_f32 v43, -v124, v91, v43
    v_mul_f32 v43, v43, v6
    v_fma_f32 v44, -v124, v92, v44
    v_mul_f32 v44, v44, v6
    v_fma_f32 v45, -v124, v93, v45
    v_mul_f32 v45, v45, v6
    v_fma_f32 v46, -v124, v94, v46
    v_mul_f32 v46, v46, v6
    v_fma_f32 v47, -v124, v95, v47
    v_mul_f32 v47, v47, v6
    v_cvt_pk_bf16_f32 v8, v32, v33
    v_cvt_pk_bf16_f32 v9, v34, v35
    v_cvt_pk_bf16_f32 v10, v36, v37
    v_cvt_pk_bf16_f32 v11, v38, v39
    v_cvt_pk_bf16_f32 v68, v40, v41
    v_cvt_pk_bf16_f32 v69, v42, v43
    v_cvt_pk_bf16_f32 v70, v44, v45
    v_cvt_pk_bf16_f32 v71, v46, v47
    ds_write_b128 v7, v[68:71]
    s_branch F_attn1
F_kv:
    s_setprio 3
    v_add_u32 v16, s36, v11
    v_add_u32 v17, s36, v12
    v_add_u32 v18, s36, v13
    v_add_u32 v19, s36, v14
    v_add_u32 v20, s36, v15
    s_add_u32 s36, s36, 28672
    s_cmp_eq_u32 s36, 143360
    s_cselect_b32 s36, 0, s36
    s_barrier
    ds_read_b128 v[64:67], v16
    ds_read_b64_tr_b16 v[80:81], v20 offset:8192
    ds_read_b64_tr_b16 v[82:83], v20 offset:8448
    ds_read_b128 v[68:71], v17
    ds_read_b64_tr_b16 v[88:89], v20 offset:9216
    ds_read_b64_tr_b16 v[90:91], v20 offset:9472
    ds_read_b128 v[72:75], v18
    ds_read_b64_tr_b16 v[96:97], v20 offset:10240
    ds_read_b64_tr_b16 v[98:99], v20 offset:10496
    ds_read_b128 v[76:79], v19
    ds_read_b64_tr_b16 v[104:105], v20 offset:11264
    ds_read_b64_tr_b16 v[106:107], v20 offset:11520
F_c1_loop:
    s_waitcnt lgkmcnt(9)
    v_mfma_f32_32x32x16_bf16 v[32:47], v[64:67], v[80:83], v[32:47]
    s_waitcnt lgkmcnt(6)
    v_mfma_f32_32x32x16_bf16 v[32:47], v[68:71], v[88:91], v[32:47]
    s_cmp_eq_u32 s26, 2
    s_cbranch_scc0 F_c1_nocs0_2
    v_mfma_f32_16x16x32_bf16 v[120:123], v[112:115], v[80:83], v[120:123]
    v_mfma_f32_16x16x32_bf16 v[120:123], v[112:115], v[88:91], v[120:123]
F_c1_nocs0_2:
    s_sub_u32 s39, s39, 1
    s_cmp_eq_u32 s39, 0
    s_cbranch_scc1 F_c1_last
    v_add_u32 v16, s36, v11
    v_add_u32 v17, s36, v12
    v_add_u32 v18, s36, v13
    v_add_u32 v19, s36, v14
    v_add_u32 v20, s36, v15
    s_add_u32 s36, s36, 28672
    s_cmp_eq_u32 s36, 143360
    s_cselect_b32 s36, 0, s36
    s_cmp_eq_u32 s39, 6
    s_cbranch_scc0 F_c1_noxf
    s_waitcnt vmcnt(0)
    v_readfirstlane_b32 s68, v116
    v_readfirstlane_b32 s69, v117
    s_cmp_eq_u32 s68, 0
    s_cbranch_scc0 F_c1_hn
Lr5:
    buffer_load_dwordx2 v[128:129], v118, s[52:55], 0 offen sc1
    s_waitcnt vmcnt(0)
    v_readfirstlane_b32 s68, v128
    v_readfirstlane_b32 s69, v129
    s_cmp_eq_u32 s68, 0
    s_cbranch_scc1 Lr5
F_c1_hn:
    s_mov_b64 exec, 1
    ds_add_rtn_u32 v128, v118, v119 offset:4
    s_waitcnt lgkmcnt(0)
    v_readfirstlane_b32 s29, v128
    s_cmp_eq_u32 s29, 7
    s_cbranch_scc0 F_c1_px
    v_mov_b32 v128, s68
    v_mov_b32 v129, s69
    buffer_store_dwordx2 v[128:129], v118, s[20:23], s59 offen sc1
F_c1_px:
    s_mov_b64 exec, -1
F_c1_noxf:
    s_cmp_gt_u32 s39, 3
    s_cbranch_scc1 F_c1_stx
    s_cmp_eq_u32 s62, 1
    s_cbranch_scc1 F_c1_stx
    s_cmp_eq_u32 s62, 0
    s_cbranch_scc1 F_c1_sti
    s_waitcnt vmcnt(0)
    v_cmp_ne_u64 vcc, s[68:69], v[130:131]
    s_nop 1
    s_cmp_eq_u64 vcc, 0
    s_cbranch_scc0 F_c1_sti
    buffer_load_dwordx2 v[124:125], v23, s[20:23], s61 offen sc1
    s_mov_b32 s62, 1
    s_branch F_c1_stx
F_c1_sti:
    buffer_load_dwordx2 v[130:131], v138, s[20:23], s60 offen sc1
    s_mov_b32 s62, 2
F_c1_stx:
    s_waitcnt lgkmcnt(0)
    s_barrier
    ds_read_b128 v[64:67], v16
    ds_read_b64_tr_b16 v[80:81], v20 offset:8192
    ds_read_b64_tr_b16 v[82:83], v20 offset:8448
    ds_read_b128 v[68:71], v17
    ds_read_b64_tr_b16 v[88:89], v20 offset:9216
    ds_read_b64_tr_b16 v[90:91], v20 offset:9472
    v_mfma_f32_32x32x16_bf16 v[32:47], v[72:75], v[96:99], v[32:47]
    v_mfma_f32_32x32x16_bf16 v[32:47], v[76:79], v[104:107], v[32:47]
    s_cmp_eq_u32 s26, 2
    s_cbranch_scc0 F_c1_nocs1_2
    v_mfma_f32_16x16x32_bf16 v[120:123], v[112:115], v[96:99], v[120:123]
    v_mfma_f32_16x16x32_bf16 v[120:123], v[112:115], v[104:107], v[120:123]
F_c1_nocs1_2:
    ds_read_b128 v[72:75], v18
    ds_read_b64_tr_b16 v[96:97], v20 offset:10240
    ds_read_b64_tr_b16 v[98:99], v20 offset:10496
    ds_read_b128 v[76:79], v19
    ds_read_b64_tr_b16 v[104:105], v20 offset:11264
    ds_read_b64_tr_b16 v[106:107], v20 offset:11520
    s_branch F_c1_loop
F_c1_last:
    s_waitcnt lgkmcnt(0)
    v_mfma_f32_32x32x16_bf16 v[32:47], v[72:75], v[96:99], v[32:47]
    v_mfma_f32_32x32x16_bf16 v[32:47], v[76:79], v[104:107], v[32:47]
    s_cmp_eq_u32 s26, 2
    s_cbranch_scc0 F_c1x_nocs1_2
    v_mfma_f32_16x16x32_bf16 v[120:123], v[112:115], v[96:99], v[120:123]
    v_mfma_f32_16x16x32_bf16 v[120:123], v[112:115], v[104:107], v[120:123]
F_c1x_nocs1_2:
    s_cmp_eq_u32 s62, 1
    s_cbranch_scc1 F_c1x_sux
    s_cmp_eq_u32 s62, 0
    s_cbranch_scc1 F_c1x_sui
    s_waitcnt vmcnt(0)
    v_cmp_ne_u64 vcc, s[68:69], v[130:131]
    s_nop 1
    s_cmp_eq_u64 vcc, 0
    s_cbranch_scc0 F_c1x_sui
    buffer_load_dwordx2 v[124:125], v23, s[20:23], s61 offen sc1
    s_mov_b32 s62, 1
    s_branch F_c1x_sux
F_c1x_sui:
    buffer_load_dwordx2 v[130:131], v138, s[20:23], s60 offen sc1
    s_mov_b32 s62, 2
F_c1x_sux:
    v_lshlrev_b32 v4, 2, v0
    v_cmp_gt_u32 vcc, 16, v0
    s_mov_b32 s34, 256
    s_cmp_eq_u32 s26, 2
    s_cselect_b32 s34, s34, 512
    v_mov_b32 v5, 512
    v_mov_b32 v6, s34
    v_cndmask_b32 v5, v5, v6, vcc
    v_add_u32 v5, v5, v4
    v_add_u32 v5, 144128, v5
    s_nop 1
    ds_write_b32 v5, v120
    ds_write_b32 v5, v121 offset:64
    v_and_b32 v6, 31, v0
    s_lshl_b32 s34, s26, 8
    s_add_u32 s34, s34, 145152
    v_lshl_add_u32 v7, v6, 3, s34
    v_lshlrev_b32 v6, 2, v6
    v_lshrrev_b32 v8, 5, v0
    v_lshlrev_b32 v8, 4, v8
    s_lshl_b32 s37, s25, 7
    s_lshl_b32 s35, s24, 2
    s_add_u32 s37, s37, s35
    s_add_u32 s37, s37, s26
    s_waitcnt lgkmcnt(0)
    s_mov_b64 exec, 1
    ds_add_u32 v118, v119 offset:12
    s_mov_b64 exec, -1
Lw6:
    ds_read_b32 v9, v118 offset:12
    s_waitcnt lgkmcnt(0)
    v_readfirstlane_b32 s29, v9
    s_cmp_ge_u32 s29, 8
    s_cbranch_scc1 Lw6x
    s_branch Lw6
Lw6x:
    v_add_u32 v9, 144128, v6
    ds_read_b32 v4, v9 offset:256
    s_cmp_eq_u32 s62, 1
    s_cbranch_scc1 F_c1x_svx
    s_cmp_eq_u32 s62, 0
    s_cbranch_scc1 F_c1x_svi
    s_waitcnt vmcnt(0)
    v_cmp_ne_u64 vcc, s[68:69], v[130:131]
    s_nop 1
    s_cmp_eq_u64 vcc, 0
    s_cbranch_scc0 F_c1x_svi
    buffer_load_dwordx2 v[124:125], v23, s[20:23], s61 offen sc1
    s_mov_b32 s62, 1
    s_branch F_c1x_svx
F_c1x_svi:
F_c1x_svx:
    s_cmp_eq_u32 s62, 1
    s_cbranch_scc1 F_c1x_sok
Lq7:
    buffer_load_dwordx2 v[128:129], v138, s[20:23], s60 offen sc1
    s_waitcnt vmcnt(0)
    v_cmp_ne_u64 vcc, s[68:69], v[128:129]
    s_nop 1
    s_cmp_eq_u64 vcc, 0
    s_cbranch_scc1 Lq7x
    s_branch Lq7
Lq7x:
    buffer_load_dwordx2 v[124:125], v23, s[20:23], s61 offen sc1
F_c1x_sok:
    s_waitcnt vmcnt(0)
    s_lshl_b32 s34, s3, 8
    s_add_u32 s34, s34, 147200
    v_add_u32 v6, s34, v6
    v_add_u32 v8, s34, v8
    ds_write_b32 v6, v124
    ds_write_b32 v6, v125 offset:128
    ds_read_b128 v[80:83], v8 offset:0
    ds_read_b128 v[84:87], v8 offset:32
    ds_read_b128 v[88:91], v8 offset:64
    ds_read_b128 v[92:95], v8 offset:96
    ds_read_b128 v[96:99], v8 offset:128
    ds_read_b128 v[100:103], v8 offset:160
    ds_read_b128 v[104:107], v8 offset:192
    ds_read_b128 v[108:111], v8 offset:224
    v_bfe_u32 v7, v0, 4, 1
    v_lshlrev_b32 v7, 17, v7
    v_lshrrev_b32 v5, 5, v0
    v_lshl_add_u32 v7, v5, 8, v7
    v_and_b32 v5, 15, v0
    v_lshl_add_u32 v7, v5, 4, v7
    s_lshl_b32 s35, s37, 11
    s_add_u32 s35, s35, 2097152
    s_waitcnt lgkmcnt(0)
    v_fma_f32 v32, -v80, v4, v32
    v_mul_f32 v32, v32, v96
    v_fma_f32 v33, -v81, v4, v33
    v_mul_f32 v33, v33, v97
    v_fma_f32 v34, -v82, v4, v34
    v_mul_f32 v34, v34, v98
    v_fma_f32 v35, -v83, v4, v35
    v_mul_f32 v35, v35, v99
    v_fma_f32 v36, -v84, v4, v36
    v_mul_f32 v36, v36, v100
    v_fma_f32 v37, -v85, v4, v37
    v_mul_f32 v37, v37, v101
    v_fma_f32 v38, -v86, v4, v38
    v_mul_f32 v38, v38, v102
    v_fma_f32 v39, -v87, v4, v39
    v_mul_f32 v39, v39, v103
    v_fma_f32 v40, -v88, v4, v40
    v_mul_f32 v40, v40, v104
    v_fma_f32 v41, -v89, v4, v41
    v_mul_f32 v41, v41, v105
    v_fma_f32 v42, -v90, v4, v42
    v_mul_f32 v42, v42, v106
    v_fma_f32 v43, -v91, v4, v43
    v_mul_f32 v43, v43, v107
    v_fma_f32 v44, -v92, v4, v44
    v_mul_f32 v44, v44, v108
    v_fma_f32 v45, -v93, v4, v45
    v_mul_f32 v45, v45, v109
    v_fma_f32 v46, -v94, v4, v46
    v_mul_f32 v46, v46, v110
    v_fma_f32 v47, -v95, v4, v47
    v_mul_f32 v47, v47, v111
    v_cvt_pk_bf16_f32 v64, v32, v33
    v_cvt_pk_bf16_f32 v65, v34, v35
    v_cvt_pk_bf16_f32 v66, v36, v37
    v_cvt_pk_bf16_f32 v67, v38, v39
    v_cvt_pk_bf16_f32 v68, v40, v41
    v_cvt_pk_bf16_f32 v69, v42, v43
    v_cvt_pk_bf16_f32 v70, v44, v45
    v_cvt_pk_bf16_f32 v71, v46, v47
    buffer_store_dwordx4 v[64:67], v7, s[20:23], s35 offen offset:1024 sc1
    buffer_store_dwordx4 v[68:71], v7, s[20:23], s35 offen offset:1536 sc1
    v_lshrrev_b32 v5, 2, v7
    v_and_b32 v5, 0x8000, v5
    v_and_b32 v6, 0x3ff, v7
    v_add_u32 v5, v5, v6
    s_lshl_b32 s35, s26, 11
    s_add_u32 s35, s35, 88064
    v_add_u32 v5, s35, v5
    ds_write_b128 v5, v[64:67]
    ds_write_b128 v5, v[68:71] offset:512
F_attn1:
    s_setprio 0
F_attn2:
    s_lshr_b32 s36, s3, 2
    s_lshl_b32 s16, s25, 1
    s_add_u32 s16, s16, s36
    s_lshl_b32 s17, s24, 2
    s_add_u32 s17, s17, s26
    s_lshl_b32 s41, s25, 4
    s_add_u32 s41, s41, s24
    s_lshl_b32 s41, s41, 7
    s_add_u32 s41, s41, 31490048
    s_lshl_b32 s40, s25, 11
    s_add_u32 s40, s40, 31490048
    s_lshl_b32 s18, s24, 4
    s_add_u32 s18, s18, s25
    s_lshl_b32 s18, s18, 7
    s_add_u32 s18, s18, 31555584
    s_add_u32 s37, s24, 1
    s_and_b32 s37, s37, 15
    s_lshl_b32 s39, s26, 11
    s_lshl_b32 s26, s16, 17
    s_add_u32 s26, s26, 2097152
    s_add_u32 s38, s26, s39
    s_lshl_b32 s29, s36, 15
    s_add_u32 s29, s29, 87040
    s_add_u32 s27, s29, s39
    v_lshrrev_b32 v3, 5, v0
    v_lshlrev_b32 v3, 8, v3
    v_and_b32 v4, 15, v0
    v_lshlrev_b32 v120, 7, v4
    v_lshlrev_b32 v4, 4, v4
    v_add_u32 v3, v3, v4
    v_add_u32 v108, s29, v2
    s_add_u32 s29, s29, 1024
    v_add_u32 v109, s29, v3
    s_lshl_b32 s29, s3, 2
    s_add_u32 s29, s29, 128
    v_mov_b32 v114, s29
    v_mov_b32 v115, 1
    v_and_b32 v117, 7, v0
    v_lshlrev_b32 v117, 2, v117
    v_mov_b32 v118, 0
    v_mov_b32 v119, 1
    s_mov_b32 s24, 0x0000ffff
    s_mov_b32 s25, 0x0000ffff
    s_lshl_b32 s29, s36, 2
    s_lshl_b32 s63, 0xf, s29
    s_waitcnt lgkmcnt(0)
    s_mov_b64 exec, 1
    ds_write_b32 v114, v115
    s_mov_b64 exec, -1
    v_and_b32 v4, 27, v0
    v_cmp_eq_u32 vcc, 16, v4
    v_mov_b32 v5, 0x3f803f80
    s_nop 0
    v_cndmask_b32 v5, 0, v5, vcc
    v_mov_b32 v100, v5
    v_mov_b32 v101, v5
    v_mov_b32 v102, v5
    v_mov_b32 v103, v5
    v_mov_b32 v104, v5
    v_mov_b32 v105, v5
    v_mov_b32 v106, v5
    v_mov_b32 v107, v5
    v_mov_b32 v80, 0
    v_mov_b32 v81, 0
    v_mov_b32 v82, 0
    v_mov_b32 v83, 0
    v_mov_b32 v84, 0
    v_mov_b32 v85, 0
    v_mov_b32 v86, 0
    v_mov_b32 v87, 0
    v_mov_b32 v88, 0
    v_mov_b32 v89, 0
    v_mov_b32 v90, 0
    v_mov_b32 v91, 0
    v_mov_b32 v92, 0
    v_mov_b32 v93, 0
    v_mov_b32 v94, 0
    v_mov_b32 v95, 0
    v_mov_b32 v76, 0
    v_mov_b32 v77, 0
    v_mov_b32 v78, 0
    v_mov_b32 v79, 0
    s_mov_b32 s72, s46
    s_mov_b32 s73, s47
    s_mov_b32 s74, 1835008
    s_mov_b32 s75, 0x00020000
    s_mov_b32 s76, s42
    s_mov_b32 s77, s43
    s_mov_b32 s78, 524288
    s_mov_b32 s79, 0x00020000
    s_bfe_u32 s70, s2, 0x30003
    s_bfe_u32 s71, s2, 0x10002
    s_lshl_b32 s71, s71, 2
    s_lshr_b32 s64, s2, 6
    s_add_u32 s71, s71, s64
    s_lshl_b32 s71, s71, 7
    s_mul_i32 s64, s70, 224
    s_mul_i32 s65, s3, 28
    s_add_u32 s64, s64, s65
    s_lshl_b32 s64, s64, 10
    s_add_u32 s64, s64, s71
    s_lshl_b32 s65, s70, 3
    s_add_u32 s65, s65, s3
    s_lshl_b32 s65, s65, 13
    s_add_u32 s65, s65, s71
    v_lshrrev_b32 v131, 3, v0
    v_and_b32 v132, 7, v0
    v_bfe_u32 v133, v0, 4, 1
    v_lshlrev_b32 v133, 2, v133
    v_xor_b32 v132, v132, v133
    v_lshlrev_b32 v131, 10, v131
    v_lshl_add_u32 v131, v132, 4, v131
    v_add_u32 v131, s71, v131
    v_add_u32 v132, 8192, v131
    s_lshl_b32 s66, s36, 18
    s_and_b32 s67, s3, 3
    s_lshl_b32 s67, s67, 14
    s_add_u32 s66, s66, s67
    v_min_u32 v127, 27, v0
    v_lshlrev_b32 v127, 10, v127
    v_and_b32 v128, 7, v0
    v_lshlrev_b32 v128, 10, v128
    s_and_b32 s29, s3, 3
    s_lshl_b32 s29, s29, 10
    s_add_u32 s29, s29, 152576
    v_add_u32 v4, s29, v2
F_aw0:
    ds_read_b32 v116, v117 offset:128
    s_waitcnt lgkmcnt(0)
    v_cmp_eq_u32 vcc, 0, v116
    s_nop 1
    s_cmp_eq_u64 vcc, 0
    s_cbranch_scc0 F_aw0
    s_cmp_eq_u32 s36, 0
    s_cbranch_scc1 F_hq
    ds_read_b128 v[8:11], v4
F_hq:
    ds_read_b128 v[96:99], v108
    s_mov_b64 exec, s[24:25]
    ds_read_b128 v[100:103], v109
    s_mov_b64 exec, -1
    s_waitcnt lgkmcnt(0)
    v_mfma_f32_32x32x16_bf16 v[32:47], v[96:99], v[8:11], 0
    v_mov_b32 v115, 2
    s_mov_b32 s30, 8192
    s_mov_b32 s31, 3
    s_mov_b32 s33, 0
    s_mov_b32 s34, 15
    s_xor_b32 s35, s3, 4
    s_mov_b32 s62, 0
    s_nop 4
    v_max3_f32 v6, v32, v33, v34
    v_max3_f32 v6, v6, v35, v36
    v_max3_f32 v6, v6, v37, v38
    v_max3_f32 v6, v6, v39, v40
    v_max3_f32 v6, v6, v41, v42
    v_max3_f32 v6, v6, v43, v44
    v_max3_f32 v6, v6, v45, v46
    v_max_f32 v6, v6, v47
    v_mov_b32 v4, v6
    s_nop 1
    v_permlane32_swap_b32 v4, v6
    s_nop 1
    v_max_f32 v6, v4, v6
    v_sub_f32 v6, 0, v6
    v_mov_b32 v16, v6
    v_mov_b32 v17, v6
    v_mov_b32 v18, v6
    v_mov_b32 v19, v6
    v_mov_b32 v20, v6
    v_mov_b32 v21, v6
    v_mov_b32 v22, v6
    v_mov_b32 v23, v6
    v_mov_b32 v24, v6
    v_mov_b32 v25, v6
    v_mov_b32 v26, v6
    v_mov_b32 v27, v6
    v_mov_b32 v28, v6
    v_mov_b32 v29, v6
    v_mov_b32 v30, v6
    v_mov_b32 v31, v6
    v_mov_b32 v62, 0
    v_mov_b32 v63, 0
    v_mfma_f32_32x32x16_bf16 v[32:47], v[96:99], v[8:11], v[16:31]
    ds_read_b128 v[96:99], v108 offset:2048
    s_waitcnt lgkmcnt(0)
    s_nop 7
    s_nop 1
    v_exp_f32 v32, v32
    v_cvt_pk_bf16_f32 v79, v62, v63
    v_exp_f32 v33, v33
    s_waitcnt lgkmcnt(0)
    v_mfma_f32_32x32x16_bf16 v[48:63], v[96:99], v[8:11], v[16:31]
    ds_read_b128 v[96:99], v108 offset:4096
    v_exp_f32 v34, v34
    v_cvt_pk_bf16_f32 v64, v32, v33
    v_exp_f32 v35, v35
    v_exp_f32 v36, v36
    v_cvt_pk_bf16_f32 v65, v34, v35
    s_waitcnt lgkmcnt(0)
    v_mfma_f32_32x32x16_bf16 v[80:95], v[104:107], v[76:79], v[80:95]
    s_mov_b64 exec, s[24:25]
    ds_read_b128 v[104:107], v109 offset:512
    s_mov_b64 exec, -1
    v_exp_f32 v37, v37
    v_exp_f32 v38, v38
    v_cvt_pk_bf16_f32 v66, v36, v37
    v_exp_f32 v39, v39
    v_exp_f32 v40, v40
    v_cvt_pk_bf16_f32 v67, v38, v39
    v_exp_f32 v41, v41
    v_exp_f32 v42, v42
    s_waitcnt lgkmcnt(0)
    v_mfma_f32_32x32x16_bf16 v[80:95], v[100:103], v[64:67], v[80:95]
    s_mov_b64 exec, s[24:25]
    ds_read_b128 v[100:103], v109 offset:2048
    s_mov_b64 exec, -1
    v_cvt_pk_bf16_f32 v68, v40, v41
    v_exp_f32 v43, v43
    v_exp_f32 v44, v44
    v_cvt_pk_bf16_f32 v69, v42, v43
    v_exp_f32 v45, v45
    v_exp_f32 v46, v46
    v_cvt_pk_bf16_f32 v70, v44, v45
    v_exp_f32 v47, v47
    s_waitcnt vmcnt(0)
    s_mov_b64 exec, 1
    ds_add_rtn_u32 v124, v118, v119 offset:20
    s_waitcnt lgkmcnt(0)
    v_readfirstlane_b32 s29, v124
    s_cmp_eq_u32 s29, 7
    s_cbranch_scc0 F_pa
    v_mov_b32 v124, s68
    v_mov_b32 v125, s69
    buffer_store_dwordx2 v[124:125], v118, s[20:23], s41 offen sc1
F_pa:
    s_mov_b64 exec, -1
    s_cmp_eq_u32 s3, 0
    s_cbranch_scc0 F_npl
    buffer_load_dwordx2 v[122:123], v120, s[20:23], s40 offen sc1
F_npl:
    v_exp_f32 v48, v48
    v_cvt_pk_bf16_f32 v71, v46, v47
    v_exp_f32 v49, v49
    s_waitcnt lgkmcnt(0)
    v_mfma_f32_32x32x16_bf16 v[32:47], v[96:99], v[8:11], v[16:31]
    ds_read_b128 v[96:99], v108 offset:6144
    v_exp_f32 v50, v50
    v_cvt_pk_bf16_f32 v72, v48, v49
    v_exp_f32 v51, v51
    v_exp_f32 v52, v52
    v_cvt_pk_bf16_f32 v73, v50, v51
    s_waitcnt lgkmcnt(0)
    v_mfma_f32_32x32x16_bf16 v[80:95], v[104:107], v[68:71], v[80:95]
    s_mov_b64 exec, s[24:25]
    ds_read_b128 v[104:107], v109 offset:2560
    s_mov_b64 exec, -1
    v_exp_f32 v53, v53
    v_exp_f32 v54, v54
    v_cvt_pk_bf16_f32 v74, v52, v53
    v_exp_f32 v55, v55
    v_exp_f32 v56, v56
    v_cvt_pk_bf16_f32 v75, v54, v55
    v_exp_f32 v57, v57
    v_exp_f32 v58, v58
    s_waitcnt lgkmcnt(0)
    v_mfma_f32_32x32x16_bf16 v[80:95], v[100:103], v[72:75], v[80:95]
    s_mov_b64 exec, s[24:25]
    ds_read_b128 v[100:103], v109 offset:4096
    s_mov_b64 exec, -1
    v_cvt_pk_bf16_f32 v76, v56, v57
    v_exp_f32 v59, v59
    v_exp_f32 v60, v60
    v_cvt_pk_bf16_f32 v77, v58, v59
    v_exp_f32 v61, v61
    v_exp_f32 v62, v62
    v_cvt_pk_bf16_f32 v78, v60, v61
    v_exp_f32 v63, v63
    s_cmp_eq_u32 s62, 1
    s_cbranch_scc1 F_gc1x
    s_cmp_eq_u32 s3, 0
    s_cbranch_scc0 F_gc1n
    s_waitcnt vmcnt(0)
    v_cmp_ne_u64 vcc, s[68:69], v[122:123]
    s_nop 1
    s_cmp_eq_u64 vcc, 0
    s_cbranch_scc1 F_gc1y
    buffer_load_dwordx2 v[122:123], v120, s[20:23], s40 offen sc1
    s_branch F_gc1x
F_gc1y:
    s_mov_b64 exec, 1
    ds_add_u32 v118, v119 offset:28
    s_mov_b64 exec, -1
    s_branch F_gc1g
F_gc1n:
    ds_read_b32 v126, v118 offset:28
    s_waitcnt lgkmcnt(0)
    v_readfirstlane_b32 s29, v126
    s_cmp_eq_u32 s29, 0
    s_cbranch_scc1 F_gc1x
F_gc1g:
    s_add_u32 m0, s27, 8192
    s_lshl_b32 s28, s37, 13
    s_add_u32 s28, s28, s38
    buffer_load_dwordx4 v2, s[20:23], s28 offen sc1 lds
    buffer_load_dwordx4 v2, s[20:23], s28 offen offset:1024 sc1 lds
    s_add_u32 s37, s37, 1
    s_and_b32 s37, s37, 15
    s_add_u32 m0, s27, 16384
    s_lshl_b32 s28, s37, 13
    s_add_u32 s28, s28, s38
    buffer_load_dwordx4 v2, s[20:23], s28 offen sc1 lds
    buffer_load_dwordx4 v2, s[20:23], s28 offen offset:1024 sc1 lds
    s_add_u32 s37, s37, 1
    s_and_b32 s37, s37, 15
    s_add_u32 m0, s27, 24576
    s_lshl_b32 s28, s37, 13
    s_add_u32 s28, s28, s38
    buffer_load_dwordx4 v2, s[20:23], s28 offen sc1 lds
    buffer_load_dwordx4 v2, s[20:23], s28 offen offset:1024 sc1 lds
    s_add_u32 s37, s37, 1
    s_and_b32 s37, s37, 15
    s_mov_b32 s62, 1
F_gc1x:
    v_exp_f32 v32, v32
    v_cvt_pk_bf16_f32 v79, v62, v63
    v_exp_f32 v33, v33
    s_waitcnt lgkmcnt(0)
    v_mfma_f32_32x32x16_bf16 v[48:63], v[96:99], v[8:11], v[16:31]
    v_exp_f32 v34, v34
    v_cvt_pk_bf16_f32 v64, v32, v33
    v_exp_f32 v35, v35
    v_exp_f32 v36, v36
    v_cvt_pk_bf16_f32 v65, v34, v35
    s_waitcnt lgkmcnt(0)
    v_mfma_f32_32x32x16_bf16 v[80:95], v[104:107], v[76:79], v[80:95]
    s_mov_b64 exec, s[24:25]
    ds_read_b128 v[104:107], v109 offset:4608
    s_mov_b64 exec, -1
    v_exp_f32 v37, v37
    v_exp_f32 v38, v38
    v_cvt_pk_bf16_f32 v66, v36, v37
    v_exp_f32 v39, v39
    v_exp_f32 v40, v40
    v_cvt_pk_bf16_f32 v67, v38, v39
    v_exp_f32 v41, v41
    v_exp_f32 v42, v42
    s_waitcnt lgkmcnt(0)
    v_mfma_f32_32x32x16_bf16 v[80:95], v[100:103], v[64:67], v[80:95]
    s_mov_b64 exec, s[24:25]
    ds_read_b128 v[100:103], v109 offset:6144
    s_mov_b64 exec, -1
    v_cvt_pk_bf16_f32 v68, v40, v41
    v_exp_f32 v43, v43
    v_exp_f32 v44, v44
    v_cvt_pk_bf16_f32 v69, v42, v43
    v_exp_f32 v45, v45
    v_exp_f32 v46, v46
    v_cvt_pk_bf16_f32 v70, v44, v45
    v_exp_f32 v47, v47
    s_cmp_eq_u32 s62, 1
    s_cbranch_scc1 F_gc2x
    s_cmp_eq_u32 s3, 0
    s_cbranch_scc0 F_gc2n
    s_waitcnt vmcnt(0)
    v_cmp_ne_u64 vcc, s[68:69], v[122:123]
    s_nop 1
    s_cmp_eq_u64 vcc, 0
    s_cbranch_scc1 F_gc2y
    buffer_load_dwordx2 v[122:123], v120, s[20:23], s40 offen sc1
    s_branch F_gc2x
F_gc2y:
    s_mov_b64 exec, 1
    ds_add_u32 v118, v119 offset:28
    s_mov_b64 exec, -1
    s_branch F_gc2g
F_gc2n:
    ds_read_b32 v126, v118 offset:28
    s_waitcnt lgkmcnt(0)
    v_readfirstlane_b32 s29, v126
    s_cmp_eq_u32 s29, 0
    s_cbranch_scc1 F_gc2x
F_gc2g:
    s_add_u32 m0, s27, 8192
    s_lshl_b32 s28, s37, 13
    s_add_u32 s28, s28, s38
    buffer_load_dwordx4 v2, s[20:23], s28 offen sc1 lds
    buffer_load_dwordx4 v2, s[20:23], s28 offen offset:1024 sc1 lds
    s_add_u32 s37, s37, 1
    s_and_b32 s37, s37, 15
    s_add_u32 m0, s27, 16384
    s_lshl_b32 s28, s37, 13
    s_add_u32 s28, s28, s38
    buffer_load_dwordx4 v2, s[20:23], s28 offen sc1 lds
    buffer_load_dwordx4 v2, s[20:23], s28 offen offset:1024 sc1 lds
    s_add_u32 s37, s37, 1
    s_and_b32 s37, s37, 15
    s_add_u32 m0, s27, 24576
    s_lshl_b32 s28, s37, 13
    s_add_u32 s28, s28, s38
    buffer_load_dwordx4 v2, s[20:23], s28 offen sc1 lds
    buffer_load_dwordx4 v2, s[20:23], s28 offen offset:1024 sc1 lds
    s_add_u32 s37, s37, 1
    s_and_b32 s37, s37, 15
    s_mov_b32 s62, 1
F_gc2x:
    v_exp_f32 v48, v48
    v_cvt_pk_bf16_f32 v71, v46, v47
    v_exp_f32 v49, v49
    s_waitcnt lgkmcnt(0)
    v_exp_f32 v50, v50
    v_cvt_pk_bf16_f32 v72, v48, v49
    v_exp_f32 v51, v51
    v_exp_f32 v52, v52
    v_cvt_pk_bf16_f32 v73, v50, v51
    s_waitcnt lgkmcnt(0)
    v_mfma_f32_32x32x16_bf16 v[80:95], v[104:107], v[68:71], v[80:95]
    s_mov_b64 exec, s[24:25]
    ds_read_b128 v[104:107], v109 offset:6656
    s_mov_b64 exec, -1
    v_exp_f32 v53, v53
    v_exp_f32 v54, v54
    v_cvt_pk_bf16_f32 v74, v52, v53
    v_exp_f32 v55, v55
    v_exp_f32 v56, v56
    v_cvt_pk_bf16_f32 v75, v54, v55
    v_exp_f32 v57, v57
    v_exp_f32 v58, v58
    s_waitcnt lgkmcnt(0)
    v_mfma_f32_32x32x16_bf16 v[80:95], v[100:103], v[72:75], v[80:95]
    v_cvt_pk_bf16_f32 v76, v56, v57
    v_exp_f32 v59, v59
    v_exp_f32 v60, v60
    v_cvt_pk_bf16_f32 v77, v58, v59
    v_exp_f32 v61, v61
    v_exp_f32 v62, v62
    v_cvt_pk_bf16_f32 v78, v60, v61
    v_exp_f32 v63, v63
    s_cmp_eq_u32 s62, 1
    s_cbranch_scc1 F_gc3x
    s_cmp_eq_u32 s3, 0
    s_cbranch_scc0 F_gc3n
    s_waitcnt vmcnt(0)
    v_cmp_ne_u64 vcc, s[68:69], v[122:123]
    s_nop 1
    s_cmp_eq_u64 vcc, 0
    s_cbranch_scc1 F_gc3y
    buffer_load_dwordx2 v[122:123], v120, s[20:23], s40 offen sc1
    s_branch F_gc3x
F_gc3y:
    s_mov_b64 exec, 1
    ds_add_u32 v118, v119 offset:28
    s_mov_b64 exec, -1
    s_branch F_gc3g
F_gc3n:
    ds_read_b32 v126, v118 offset:28
    s_waitcnt lgkmcnt(0)
    v_readfirstlane_b32 s29, v126
    s_cmp_eq_u32 s29, 0
    s_cbranch_scc1 F_gc3x
F_gc3g:
    s_add_u32 m0, s27, 8192
    s_lshl_b32 s28, s37, 13
    s_add_u32 s28, s28, s38
    buffer_load_dwordx4 v2, s[20:23], s28 offen sc1 lds
    buffer_load_dwordx4 v2, s[20:23], s28 offen offset:1024 sc1 lds
    s_add_u32 s37, s37, 1
    s_and_b32 s37, s37, 15
    s_add_u32 m0, s27, 16384
    s_lshl_b32 s28, s37, 13
    s_add_u32 s28, s28, s38
    buffer_load_dwordx4 v2, s[20:23], s28 offen sc1 lds
    buffer_load_dwordx4 v2, s[20:23], s28 offen offset:1024 sc1 lds
    s_add_u32 s37, s37, 1
    s_and_b32 s37, s37, 15
    s_add_u32 m0, s27, 24576
    s_lshl_b32 s28, s37, 13
    s_add_u32 s28, s28, s38
    buffer_load_dwordx4 v2, s[20:23], s28 offen sc1 lds
    buffer_load_dwordx4 v2, s[20:23], s28 offen offset:1024 sc1 lds
    s_add_u32 s37, s37, 1
    s_and_b32 s37, s37, 15
    s_mov_b32 s62, 1
F_gc3x:
    s_cmp_eq_u32 s62, 1
    s_cbranch_scc1 F_started
    s_cmp_eq_u32 s3, 0
    s_cbranch_scc0 F_gw
Lq8:
    buffer_load_dwordx2 v[122:123], v120, s[20:23], s40 offen sc1
    s_waitcnt vmcnt(0)
    v_cmp_ne_u64 vcc, s[68:69], v[122:123]
    s_nop 1
    s_cmp_eq_u64 vcc, 0
    s_cbranch_scc1 Lq8x
    s_sleep 2
    s_branch Lq8
Lq8x:
    s_mov_b64 exec, 1
    ds_add_u32 v118, v119 offset:28
    s_mov_b64 exec, -1
    s_branch F_go
F_gw:
Lw9:
    ds_read_b32 v126, v118 offset:28
    s_waitcnt lgkmcnt(0)
    v_readfirstlane_b32 s29, v126
    s_cmp_ge_u32 s29, 1
    s_cbranch_scc1 Lw9x
    s_sleep 1
    s_branch Lw9
Lw9x:
    s_waitcnt vmcnt(0)
F_go:
    s_add_u32 m0, s27, 8192
    s_lshl_b32 s28, s37, 13
    s_add_u32 s28, s28, s38
    buffer_load_dwordx4 v2, s[20:23], s28 offen sc1 lds
    buffer_load_dwordx4 v2, s[20:23], s28 offen offset:1024 sc1 lds
    s_add_u32 s37, s37, 1
    s_and_b32 s37, s37, 15
    s_add_u32 m0, s27, 16384
    s_lshl_b32 s28, s37, 13
    s_add_u32 s28, s28, s38
    buffer_load_dwordx4 v2, s[20:23], s28 offen sc1 lds
    buffer_load_dwordx4 v2, s[20:23], s28 offen offset:1024 sc1 lds
    s_add_u32 s37, s37, 1
    s_and_b32 s37, s37, 15
    s_add_u32 m0, s27, 24576
    s_lshl_b32 s28, s37, 13
    s_add_u32 s28, s28, s38
    buffer_load_dwordx4 v2, s[20:23], s28 offen sc1 lds
    buffer_load_dwordx4 v2, s[20:23], s28 offen offset:1024 sc1 lds
    s_add_u32 s37, s37, 1
    s_and_b32 s37, s37, 15
F_started:
    s_waitcnt vmcnt(4)
    s_mov_b64 exec, 1
    ds_write_b32 v114, v115
    s_mov_b64 exec, -1
    v_mov_b32 v115, 3
    v_add_u32 v110, 8192, v108
    v_add_u32 v111, 8192, v109
F_aw2:
    ds_read_b32 v116, v117 offset:128
    s_waitcnt lgkmcnt(0)
    v_cmp_gt_u32 vcc, 2, v116
    s_nop 1
    s_and_b32 s29, vcc_lo, s63
    s_cbranch_scc1 F_aw2
    ds_read_b128 v[96:99], v110
    s_mov_b64 exec, s[24:25]
    ds_read_b128 v[100:103], v111
    s_mov_b64 exec, -1
    s_waitcnt lgkmcnt(0)
    v_mfma_f32_32x32x16_bf16 v[32:47], v[96:99], v[8:11], v[16:31]
    ds_read_b128 v[96:99], v110 offset:2048
    s_waitcnt lgkmcnt(0)
    s_nop 7
    s_nop 1
.p2align 6
F_aloop:
    v_exp_f32 v32, v32
    v_cvt_pk_bf16_f32 v79, v62, v63
    v_exp_f32 v33, v33
    s_waitcnt lgkmcnt(2)
    v_mfma_f32_32x32x16_bf16 v[48:63], v[96:99], v[8:11], v[16:31]
    ds_read_b128 v[96:99], v110 offset:4096
    v_exp_f32 v34, v34
    v_cvt_pk_bf16_f32 v64, v32, v33
    v_exp_f32 v35, v35
    v_exp_f32 v36, v36
    v_cvt_pk_bf16_f32 v65, v34, v35
    s_waitcnt lgkmcnt(2)
    v_mfma_f32_32x32x16_bf16 v[80:95], v[104:107], v[76:79], v[80:95]
    s_mov_b64 exec, s[24:25]
    ds_read_b128 v[104:107], v111 offset:512
    s_waitcnt vmcnt(2)
    s_mov_b64 exec, 1
    ds_write_b32 v114, v115
    s_mov_b64 exec, -1
    v_exp_f32 v37, v37
    v_exp_f32 v38, v38
    v_cvt_pk_bf16_f32 v66, v36, v37
    v_exp_f32 v39, v39
    v_exp_f32 v40, v40
    v_cvt_pk_bf16_f32 v67, v38, v39
    v_exp_f32 v41, v41
    v_exp_f32 v42, v42
    s_waitcnt lgkmcnt(3)
    v_mfma_f32_32x32x16_bf16 v[80:95], v[100:103], v[64:67], v[80:95]
    s_mov_b64 exec, s[24:25]
    ds_read_b128 v[100:103], v111 offset:2048
    s_mov_b64 exec, -1
    v_cvt_pk_bf16_f32 v68, v40, v41
    v_exp_f32 v43, v43
    v_exp_f32 v44, v44
    v_cvt_pk_bf16_f32 v69, v42, v43
    v_exp_f32 v45, v45
    v_exp_f32 v46, v46
    v_cvt_pk_bf16_f32 v70, v44, v45
    v_exp_f32 v47, v47
    v_exp_f32 v48, v48
    v_cvt_pk_bf16_f32 v71, v46, v47
    v_exp_f32 v49, v49
    s_waitcnt lgkmcnt(2)
    v_mfma_f32_32x32x16_bf16 v[32:47], v[96:99], v[8:11], v[16:31]
    ds_read_b128 v[96:99], v110 offset:6144
    v_exp_f32 v50, v50
    v_cvt_pk_bf16_f32 v72, v48, v49
    v_exp_f32 v51, v51
    v_exp_f32 v52, v52
    v_cvt_pk_bf16_f32 v73, v50, v51
    s_waitcnt lgkmcnt(2)
    v_mfma_f32_32x32x16_bf16 v[80:95], v[104:107], v[68:71], v[80:95]
    s_mov_b64 exec, s[24:25]
    ds_read_b128 v[104:107], v111 offset:2560
    s_mov_b64 exec, -1
    v_exp_f32 v53, v53
    v_exp_f32 v54, v54
    v_cvt_pk_bf16_f32 v74, v52, v53
    v_exp_f32 v55, v55
    v_exp_f32 v56, v56
    v_cvt_pk_bf16_f32 v75, v54, v55
    v_exp_f32 v57, v57
    v_exp_f32 v58, v58
    s_waitcnt lgkmcnt(2)
    v_mfma_f32_32x32x16_bf16 v[80:95], v[100:103], v[72:75], v[80:95]
    s_mov_b64 exec, s[24:25]
    ds_read_b128 v[100:103], v111 offset:4096
    s_mov_b64 exec, -1
    v_add_u32 v115, 1, v115
    v_cvt_pk_bf16_f32 v76, v56, v57
    v_exp_f32 v59, v59
    v_exp_f32 v60, v60
    v_cvt_pk_bf16_f32 v77, v58, v59
    v_exp_f32 v61, v61
    v_exp_f32 v62, v62
    v_cvt_pk_bf16_f32 v78, v60, v61
    ds_read_b32 v116, v117 offset:128
    v_exp_f32 v63, v63
    v_exp_f32 v32, v32
    v_cvt_pk_bf16_f32 v79, v62, v63
    v_exp_f32 v33, v33
    s_waitcnt lgkmcnt(0)
    v_mfma_f32_32x32x16_bf16 v[48:63], v[96:99], v[8:11], v[16:31]
    v_cmp_gt_u32 vcc, s31, v116
    s_add_u32 s30, s30, 8192
    s_and_b32 s30, s30, 0x7fff
    v_add_u32 v112, s30, v108
    v_add_u32 v113, s30, v109
    s_and_b32 s29, vcc_lo, s63
    s_cbranch_scc1 F_aspin
F_aspin_ret:
    ds_read_b128 v[96:99], v112
    v_readlane_b32 s29, v116, s35
    s_cmp_lt_u32 s29, s31
    s_cbranch_scc1 F_alow
    s_setprio 1
    s_branch F_aprio
F_alow:
    s_setprio 0
F_aprio:
    s_add_u32 s31, s31, 1
    s_cmp_gt_u32 s34, 3
    s_cbranch_scc0 F_awo
    s_add_u32 m0, s27, s33
    s_lshl_b32 s28, s37, 13
    s_add_u32 s28, s28, s38
    buffer_load_dwordx4 v2, s[20:23], s28 offen sc1 lds
    buffer_load_dwordx4 v2, s[20:23], s28 offen offset:1024 sc1 lds
    s_add_u32 s37, s37, 1
    s_and_b32 s37, s37, 15
F_awo_ret:
    s_add_u32 s33, s33, 8192
    s_and_b32 s33, s33, 0x7fff
    s_cmp_eq_u32 s34, 14
    s_cbranch_scc0 F_anodma
    buffer_load_dword v129, v127, s[72:75], s64 offen
    buffer_load_dword v130, v128, s[76:79], s65 offen
F_anodma:
    v_exp_f32 v34, v34
    v_cvt_pk_bf16_f32 v64, v32, v33
    v_exp_f32 v35, v35
    v_exp_f32 v36, v36
    v_cvt_pk_bf16_f32 v65, v34, v35
    s_waitcnt lgkmcnt(2)
    v_mfma_f32_32x32x16_bf16 v[80:95], v[104:107], v[76:79], v[80:95]
    s_mov_b64 exec, s[24:25]
    ds_read_b128 v[104:107], v111 offset:4608
    s_mov_b64 exec, -1
    v_exp_f32 v37, v37
    v_exp_f32 v38, v38
    v_cvt_pk_bf16_f32 v66, v36, v37
    v_exp_f32 v39, v39
    v_exp_f32 v40, v40
    v_cvt_pk_bf16_f32 v67, v38, v39
    v_exp_f32 v41, v41
    v_exp_f32 v42, v42
    s_waitcnt lgkmcnt(2)
    v_mfma_f32_32x32x16_bf16 v[80:95], v[100:103], v[64:67], v[80:95]
    s_mov_b64 exec, s[24:25]
    ds_read_b128 v[100:103], v111 offset:6144
    s_mov_b64 exec, -1
    v_cvt_pk_bf16_f32 v68, v40, v41
    v_exp_f32 v43, v43
    v_exp_f32 v44, v44
    v_cvt_pk_bf16_f32 v69, v42, v43
    v_exp_f32 v45, v45
    v_exp_f32 v46, v46
    v_cvt_pk_bf16_f32 v70, v44, v45
    v_exp_f32 v47, v47
    v_exp_f32 v48, v48
    v_cvt_pk_bf16_f32 v71, v46, v47
    v_exp_f32 v49, v49
    s_waitcnt lgkmcnt(2)
    v_mfma_f32_32x32x16_bf16 v[32:47], v[96:99], v[8:11], v[16:31]
    ds_read_b128 v[96:99], v112 offset:2048
    v_exp_f32 v50, v50
    v_cvt_pk_bf16_f32 v72, v48, v49
    v_exp_f32 v51, v51
    v_exp_f32 v52, v52
    v_cvt_pk_bf16_f32 v73, v50, v51
    s_waitcnt lgkmcnt(2)
    v_mfma_f32_32x32x16_bf16 v[80:95], v[104:107], v[68:71], v[80:95]
    s_mov_b64 exec, s[24:25]
    ds_read_b128 v[104:107], v111 offset:6656
    s_mov_b64 exec, -1
    v_exp_f32 v53, v53
    v_exp_f32 v54, v54
    v_cvt_pk_bf16_f32 v74, v52, v53
    v_exp_f32 v55, v55
    v_exp_f32 v56, v56
    v_cvt_pk_bf16_f32 v75, v54, v55
    v_exp_f32 v57, v57
    v_exp_f32 v58, v58
    s_waitcnt lgkmcnt(2)
    v_mfma_f32_32x32x16_bf16 v[80:95], v[100:103], v[72:75], v[80:95]
    s_mov_b64 exec, s[24:25]
    ds_read_b128 v[100:103], v113
    s_mov_b64 exec, -1
    v_cvt_pk_bf16_f32 v76, v56, v57
    v_exp_f32 v59, v59
    v_exp_f32 v60, v60
    v_cvt_pk_bf16_f32 v77, v58, v59
    v_exp_f32 v61, v61
    v_exp_f32 v62, v62
    v_cvt_pk_bf16_f32 v78, v60, v61
    v_mov_b32 v110, v112
    v_mov_b32 v111, v113
    s_sub_u32 s34, s34, 1
    s_cmp_lg_u32 s34, 0
    v_exp_f32 v63, v63
    s_cbranch_scc1 F_aloop
    s_waitcnt lgkmcnt(0)
    v_cvt_pk_bf16_f32 v79, v62, v63
    s_setprio 2
    s_nop 0
    v_mfma_f32_32x32x16_bf16 v[80:95], v[104:107], v[76:79], v[80:95]
    s_lshl_b32 s19, s17, 5
    s_add_u32 s19, s19, s16
    s_nop 4
    s_lshl_b32 s19, s19, 10
    s_add_u32 s19, s19, 6291456
    s_mov_b32 s29, 0x7b800000
    s_nop 1
    v_add_f32_e64 v4, abs(v80), v88
    v_add_f32_e64 v4, abs(v81), v4
    v_add_f32_e64 v4, abs(v82), v4
    v_add_f32_e64 v4, abs(v83), v4
    v_add_f32_e64 v4, abs(v84), v4
    v_add_f32_e64 v4, abs(v85), v4
    v_add_f32_e64 v4, abs(v86), v4
    v_add_f32_e64 v4, abs(v87), v4
    v_cmp_gt_f32 vcc, s29, v4
    s_nop 1
    s_cmp_eq_u64 vcc, -1
    s_cbranch_scc0 F_aslow
F_astore:
    v_rcp_f32 v4, v88
    s_nop 0
    v_mul_f32 v80, v80, v4
    v_mul_f32 v81, v81, v4
    v_mul_f32 v82, v82, v4
    v_mul_f32 v83, v83, v4
    v_mul_f32 v84, v84, v4
    v_mul_f32 v85, v85, v4
    v_mul_f32 v86, v86, v4
    v_mul_f32 v87, v87, v4
    v_cvt_pk_bf16_f32 v64, v80, v81
    v_cvt_pk_bf16_f32 v65, v82, v83
    v_cvt_pk_bf16_f32 v66, v84, v85
    v_cvt_pk_bf16_f32 v67, v86, v87
    buffer_store_dwordx4 v[64:67], v2, s[20:23], s19 offen sc1
    s_and_b32 s24, s2, 3
    s_lshl_b32 s24, s24, 3
    s_bfe_u32 s25, s2, 0x30003
    s_add_u32 s24, s24, s25
    s_bfe_u32 s25, s2, 0x10002
    s_lshl_b32 s25, s25, 2
    s_lshr_b32 s26, s2, 6
    s_add_u32 s25, s25, s26
    s_mov_b32 s67, s27
    s_and_b32 s26, s3, 1
    s_bfe_u32 s27, s3, 0x10001
    s_lshr_b32 s28, s3, 2
    v_mov_b32 v160, 0
    v_mov_b32 v161, 1
    v_lshrrev_b32 v3, 5, v0
    v_bfe_u32 v4, v0, 2, 2
    v_lshl_add_u32 v4, v3, 2, v4
    v_lshlrev_b32 v4, 7, v4
    v_bfe_u32 v5, v0, 4, 1
    v_lshlrev_b32 v5, 1, v5
    v_bfe_u32 v6, v0, 1, 1
    v_add_u32 v5, v5, v6
    v_bfe_u32 v6, v0, 3, 1
    v_xor_b32 v6, s27, v6
    v_lshl_add_u32 v5, v6, 2, v5
    v_lshl_add_u32 v4, v5, 4, v4
    v_and_b32 v6, 1, v0
    v_lshl_add_u32 v4, v6, 3, v4
    s_lshl_b32 s29, s28, 15
    s_add_u32 s29, s29, 87040
    v_add_u32 v4, s29, v4
    v_and_b32 v5, 31, v0
    s_lshl_b32 s29, s26, 5
    v_add_u32 v5, s29, v5
    s_lshl_b32 s29, s27, 6
    s_lshl_b32 s30, s28, 5
    s_add_u32 s29, s29, s30
    v_lshl_add_u32 v6, v3, 4, s29
    v_mul_u32_u24 v7, 272, v5
    v_lshl_add_u32 v7, v6, 1, v7
    v_add_u32 v7, 256, v7
    v_lshl_add_u32 v6, v5, 10, v6
    s_lshl_b32 s30, s24, 16
    s_lshl_b32 s31, s25, 7
    s_add_u32 s30, s30, s31
    buffer_load_dwordx4 v[152:155], v6, s[8:11], s30 offen
    s_waitcnt vmcnt(1)
    s_mov_b64 exec, 1
    ds_add_rtn_u32 v162, v160, v161 offset:24
    s_waitcnt lgkmcnt(0)
    v_readfirstlane_b32 s33, v162
    s_cmp_eq_u32 s33, 7
    s_cbranch_scc0 F_po
    v_mov_b32 v162, s68
    v_mov_b32 v163, s69
    buffer_store_dwordx2 v[162:163], v160, s[20:23], s18 offen sc1
F_po:
    s_mov_b64 exec, -1
    s_lshl_b32 s31, s24, 1
    s_add_u32 s31, s31, s26
    s_lshl_b32 s31, s31, 5
    s_lshl_b32 s32, s28, 4
    s_add_u32 s31, s31, s32
    s_lshr_b32 s32, s24, 1
    s_lshl_b32 s32, s32, 1
    s_add_u32 s32, s32, s28
    s_lshl_b32 s32, s32, 10
    s_add_u32 s32, s32, 31555584
    s_lshl_b32 s31, s31, 10
    s_add_u32 s31, s31, 6291456
    v_and_b32 v5, 7, v0
    v_lshlrev_b32 v5, 7, v5
    s_mov_b32 s12, s44
    s_mov_b32 s13, s45
    s_mov_b32 s14, 2097152
    s_mov_b32 s15, 0x00020000
Lw10:
    ds_read_b32 v162, v160 offset:24
    s_waitcnt lgkmcnt(0)
    v_readfirstlane_b32 s33, v162
    s_cmp_ge_u32 s33, 8
    s_cbranch_scc1 Lw10x
    s_sleep 1
    s_branch Lw10
Lw10x:
    s_add_u32 m0, s67, 24576
    s_nop 0
    buffer_load_dwordx4 v131, s[76:79], s66 offen lds
    s_add_u32 m0, m0, 1024
    s_nop 0
    buffer_load_dwordx4 v132, s[76:79], s66 offen lds
    ds_read_b64_tr_b16 v[8:9], v4 offset:0
    ds_read_b64_tr_b16 v[10:11], v4 offset:1024
    ds_read_b64_tr_b16 v[12:13], v4 offset:2048
    ds_read_b64_tr_b16 v[14:15], v4 offset:3072
    ds_read_b64_tr_b16 v[16:17], v4 offset:4096
    ds_read_b64_tr_b16 v[18:19], v4 offset:5120
    ds_read_b64_tr_b16 v[20:21], v4 offset:6144
    ds_read_b64_tr_b16 v[22:23], v4 offset:7168
    ds_read_b64_tr_b16 v[24:25], v4 offset:8192
    ds_read_b64_tr_b16 v[26:27], v4 offset:9216
    ds_read_b64_tr_b16 v[28:29], v4 offset:10240
    ds_read_b64_tr_b16 v[30:31], v4 offset:11264
    ds_read_b64_tr_b16 v[32:33], v4 offset:12288
    ds_read_b64_tr_b16 v[34:35], v4 offset:13312
    ds_read_b64_tr_b16 v[36:37], v4 offset:14336
    s_waitcnt lgkmcnt(9)
    ds_read_b64_tr_b16 v[38:39], v4 offset:15360
    ds_read_b64_tr_b16 v[40:41], v4 offset:16384
    ds_read_b64_tr_b16 v[42:43], v4 offset:17408
    ds_read_b64_tr_b16 v[44:45], v4 offset:18432
    ds_read_b64_tr_b16 v[46:47], v4 offset:19456
    ds_read_b64_tr_b16 v[48:49], v4 offset:20480
    s_waitcnt lgkmcnt(9)
    ds_read_b64_tr_b16 v[50:51], v4 offset:21504
    ds_read_b64_tr_b16 v[52:53], v4 offset:22528
    ds_read_b64_tr_b16 v[54:55], v4 offset:23552
    ds_read_b32 v162, v160 offset:16
    s_waitcnt lgkmcnt(0)
    v_readfirstlane_b32 s37, v162
    s_cmp_ge_u32 s37, 4
    s_cbranch_scc0 F_glate
    ds_read_b128 v[72:75], v7 offset:0
    ds_read_b128 v[76:79], v7 offset:16
    ds_read_b128 v[80:83], v7 offset:17408
    ds_read_b128 v[84:87], v7 offset:17424
    ds_read_b128 v[88:91], v7 offset:34816
    ds_read_b128 v[92:95], v7 offset:34832
    ds_read_b128 v[96:99], v7 offset:52224
    ds_read_b128 v[100:103], v7 offset:52240
    s_waitcnt lgkmcnt(4)
    v_add_f32 v72, v72, v80
    v_add_f32 v73, v73, v81
    v_add_f32 v74, v74, v82
    v_add_f32 v75, v75, v83
    v_add_f32 v76, v76, v84
    v_add_f32 v77, v77, v85
    v_add_f32 v78, v78, v86
    v_add_f32 v79, v79, v87
    s_waitcnt lgkmcnt(0)
    v_add_f32 v88, v88, v96
    v_add_f32 v89, v89, v97
    v_add_f32 v90, v90, v98
    v_add_f32 v91, v91, v99
    v_add_f32 v92, v92, v100
    v_add_f32 v93, v93, v101
    v_add_f32 v94, v94, v102
    v_add_f32 v95, v95, v103
    v_add_f32 v72, v72, v88
    v_add_f32 v73, v73, v89
    v_add_f32 v74, v74, v90
    v_add_f32 v75, v75, v91
    v_add_f32 v76, v76, v92
    v_add_f32 v77, v77, v93
    v_add_f32 v78, v78, v94
    v_add_f32 v79, v79, v95
    v_cvt_pk_bf16_f32 v80, v72, v73
    v_cvt_pk_bf16_f32 v81, v74, v75
    v_cvt_pk_bf16_f32 v82, v76, v77
    v_cvt_pk_bf16_f32 v83, v78, v79
    v_lshlrev_b32 v72, 16, v80
    v_and_b32 v73, 0xffff0000, v80
    v_lshlrev_b32 v74, 16, v81
    v_and_b32 v75, 0xffff0000, v81
    v_lshlrev_b32 v76, 16, v82
    v_and_b32 v77, 0xffff0000, v82
    v_lshlrev_b32 v78, 16, v83
    v_and_b32 v79, 0xffff0000, v83
    v_mul_f32 v80, 0xbfb8aa3b, v72
    v_mul_f32 v81, 0xbfb8aa3b, v73
    v_mul_f32 v82, 0xbfb8aa3b, v74
    v_mul_f32 v83, 0xbfb8aa3b, v75
    v_mul_f32 v84, 0xbfb8aa3b, v76
    v_mul_f32 v85, 0xbfb8aa3b, v77
    v_mul_f32 v86, 0xbfb8aa3b, v78
    v_mul_f32 v87, 0xbfb8aa3b, v79
    v_exp_f32 v80, v80
    v_exp_f32 v81, v81
    v_exp_f32 v82, v82
    v_exp_f32 v83, v83
    v_exp_f32 v84, v84
    v_exp_f32 v85, v85
    v_exp_f32 v86, v86
    v_exp_f32 v87, v87
    v_add_f32 v80, 1.0, v80
    v_add_f32 v81, 1.0, v81
    v_add_f32 v82, 1.0, v82
    v_add_f32 v83, 1.0, v83
    v_add_f32 v84, 1.0, v84
    v_add_f32 v85, 1.0, v85
    v_add_f32 v86, 1.0, v86
    v_add_f32 v87, 1.0, v87
    v_rcp_f32 v80, v80
    v_rcp_f32 v81, v81
    v_rcp_f32 v82, v82
    v_rcp_f32 v83, v83
    v_rcp_f32 v84, v84
    v_rcp_f32 v85, v85
    v_rcp_f32 v86, v86
    v_rcp_f32 v87, v87
    v_mul_f32 v72, v72, v80
    v_mul_f32 v73, v73, v81
    v_mul_f32 v74, v74, v82
    v_mul_f32 v75, v75, v83
    v_mul_f32 v76, v76, v84
    v_mul_f32 v77, v77, v85
    v_mul_f32 v78, v78, v86
    v_mul_f32 v79, v79, v87
    v_cvt_pk_bf16_f32 v156, v72, v73
    v_cvt_pk_bf16_f32 v157, v74, v75
    v_cvt_pk_bf16_f32 v158, v76, v77
    v_cvt_pk_bf16_f32 v159, v78, v79
F_glate:
    s_lshl_b32 s33, s28, 2
    v_mov_b32 v165, s33
    s_and_b32 s33, s3, 3
    s_cmp_eq_u32 s33, 0
    s_cbranch_scc0 F_gw2
Lq11:
    buffer_load_dwordx2 v[162:163], v5, s[20:23], s32 offen sc1
    s_waitcnt vmcnt(0)
    v_cmp_ne_u64 vcc, s[68:69], v[162:163]
    s_nop 1
    s_cmp_eq_u64 vcc, 0
    s_cbranch_scc1 Lq11x
    s_sleep 2
    s_branch Lq11
Lq11x:
    s_mov_b64 exec, 1
    ds_add_u32 v165, v161 offset:32
    s_mov_b64 exec, -1
    s_branch F_go2
F_gw2:
Lw12:
    ds_read_b32 v162, v165 offset:32
    s_waitcnt lgkmcnt(0)
    v_readfirstlane_b32 s33, v162
    s_cmp_ge_u32 s33, 1
    s_cbranch_scc1 Lw12x
    s_sleep 1
    s_branch Lw12
Lw12x:
    s_waitcnt vmcnt(0)
F_go2:
    buffer_load_dwordx4 v[72:75], v2, s[20:23], s31 offen offset:0 sc1
    buffer_load_dwordx4 v[76:79], v2, s[20:23], s31 offen offset:1024 sc1
    buffer_load_dwordx4 v[80:83], v2, s[20:23], s31 offen offset:2048 sc1
    buffer_load_dwordx4 v[84:87], v2, s[20:23], s31 offen offset:3072 sc1
    s_add_u32 s31, s31, 4096
    buffer_load_dwordx4 v[88:91], v2, s[20:23], s31 offen offset:0 sc1
    buffer_load_dwordx4 v[92:95], v2, s[20:23], s31 offen offset:1024 sc1
    buffer_load_dwordx4 v[96:99], v2, s[20:23], s31 offen offset:2048 sc1
    buffer_load_dwordx4 v[100:103], v2, s[20:23], s31 offen offset:3072 sc1
    s_add_u32 s31, s31, 4096
    buffer_load_dwordx4 v[104:107], v2, s[20:23], s31 offen offset:0 sc1
    buffer_load_dwordx4 v[108:111], v2, s[20:23], s31 offen offset:1024 sc1
    buffer_load_dwordx4 v[112:115], v2, s[20:23], s31 offen offset:2048 sc1
    buffer_load_dwordx4 v[116:119], v2, s[20:23], s31 offen offset:3072 sc1
    s_add_u32 s31, s31, 4096
    buffer_load_dwordx4 v[120:123], v2, s[20:23], s31 offen offset:0 sc1
    buffer_load_dwordx4 v[124:127], v2, s[20:23], s31 offen offset:1024 sc1
    buffer_load_dwordx4 v[128:131], v2, s[20:23], s31 offen offset:2048 sc1
    buffer_load_dwordx4 v[132:135], v2, s[20:23], s31 offen offset:3072 sc1
    s_mov_b64 exec, 1
    ds_add_u32 v160, v161 offset:40
    s_mov_b64 exec, -1
Lw13:
    ds_read_b32 v162, v160 offset:40
    s_waitcnt lgkmcnt(0)
    v_readfirstlane_b32 s33, v162
    s_cmp_ge_u32 s33, 8
    s_cbranch_scc1 Lw13x
    s_branch Lw13
Lw13x:
    ds_read_b64_tr_b16 v[56:57], v4 offset:24576
    ds_read_b64_tr_b16 v[58:59], v4 offset:25600
    ds_read_b64_tr_b16 v[60:61], v4 offset:26624
    ds_read_b64_tr_b16 v[62:63], v4 offset:27648
    ds_read_b64_tr_b16 v[64:65], v4 offset:28672
    ds_read_b64_tr_b16 v[66:67], v4 offset:29696
    ds_read_b64_tr_b16 v[68:69], v4 offset:30720
    ds_read_b64_tr_b16 v[70:71], v4 offset:31744
    s_waitcnt lgkmcnt(0)
    s_lshl_b32 s33, s3, 11
    s_add_u32 s33, s33, 69888
    v_add_u32 v3, s33, v2
    s_xor_b32 s33, s3, 4
    s_lshl_b32 s33, s33, 11
    s_add_u32 s33, s33, 69888
    v_add_u32 v5, s33, v2
    s_lshl_b32 s33, s3, 2
    v_mov_b32 v163, s33
    v_xor_b32 v164, 16, v163
    s_waitcnt vmcnt(15)
    v_mfma_f32_32x32x16_bf16 v[136:151], v[8:11], v[72:75], 0
    s_waitcnt vmcnt(14)
    v_mfma_f32_32x32x16_bf16 v[136:151], v[12:15], v[76:79], v[136:151]
    s_waitcnt vmcnt(13)
    v_mfma_f32_32x32x16_bf16 v[136:151], v[16:19], v[80:83], v[136:151]
    s_waitcnt vmcnt(12)
    v_mfma_f32_32x32x16_bf16 v[136:151], v[20:23], v[84:87], v[136:151]
    s_waitcnt vmcnt(11)
    v_mfma_f32_32x32x16_bf16 v[136:151], v[24:27], v[88:91], v[136:151]
    s_waitcnt vmcnt(10)
    v_mfma_f32_32x32x16_bf16 v[136:151], v[28:31], v[92:95], v[136:151]
    s_waitcnt vmcnt(9)
    v_mfma_f32_32x32x16_bf16 v[136:151], v[32:35], v[96:99], v[136:151]
    s_waitcnt vmcnt(8)
    v_mfma_f32_32x32x16_bf16 v[136:151], v[36:39], v[100:103], v[136:151]
    s_waitcnt vmcnt(7)
    v_mfma_f32_32x32x16_bf16 v[136:151], v[40:43], v[104:107], v[136:151]
    s_waitcnt vmcnt(6)
    v_mfma_f32_32x32x16_bf16 v[136:151], v[44:47], v[108:111], v[136:151]
    s_waitcnt vmcnt(5)
    v_mfma_f32_32x32x16_bf16 v[136:151], v[48:51], v[112:115], v[136:151]
    s_waitcnt vmcnt(4)
    v_mfma_f32_32x32x16_bf16 v[136:151], v[52:55], v[116:119], v[136:151]
    s_waitcnt vmcnt(3)
    v_mfma_f32_32x32x16_bf16 v[136:151], v[56:59], v[120:123], v[136:151]
    s_waitcnt vmcnt(2)
    v_mfma_f32_32x32x16_bf16 v[136:151], v[60:63], v[124:127], v[136:151]
    s_waitcnt vmcnt(1)
    v_mfma_f32_32x32x16_bf16 v[136:151], v[64:67], v[128:131], v[136:151]
    s_waitcnt vmcnt(0)
    v_mfma_f32_32x32x16_bf16 v[136:151], v[68:71], v[132:135], v[136:151]
    s_cmp_eq_u32 s28, 0
    s_cbranch_scc0 F_fk1
    s_nop 7
    s_nop 1
    ds_write_b128 v3, v[144:147]
    ds_write_b128 v3, v[148:151] offset:1024
    s_branch F_fk
F_fk1:
    s_nop 7
    s_nop 1
    ds_write_b128 v3, v[136:139]
    ds_write_b128 v3, v[140:143] offset:1024
    s_waitcnt lgkmcnt(0)
    v_mov_b32 v136, v144
    v_mov_b32 v137, v145
    v_mov_b32 v138, v146
    v_mov_b32 v139, v147
    v_mov_b32 v140, v148
    v_mov_b32 v141, v149
    v_mov_b32 v142, v150
    v_mov_b32 v143, v151
F_fk:
    s_waitcnt lgkmcnt(0)
    s_mov_b64 exec, 1
    ds_write_b32 v163, v161 offset:160
    s_mov_b64 exec, -1
    s_cmp_ge_u32 s37, 4
    s_cbranch_scc1 F_ghave
Lw14:
    ds_read_b32 v162, v160 offset:16
    s_waitcnt lgkmcnt(0)
    v_readfirstlane_b32 s33, v162
    s_cmp_ge_u32 s33, 4
    s_cbranch_scc1 Lw14x
    s_branch Lw14
Lw14x:
    ds_read_b128 v[72:75], v7 offset:0
    ds_read_b128 v[76:79], v7 offset:16
    ds_read_b128 v[80:83], v7 offset:17408
    ds_read_b128 v[84:87], v7 offset:17424
    ds_read_b128 v[88:91], v7 offset:34816
    ds_read_b128 v[92:95], v7 offset:34832
    ds_read_b128 v[96:99], v7 offset:52224
    ds_read_b128 v[100:103], v7 offset:52240
    s_waitcnt lgkmcnt(4)
    v_add_f32 v72, v72, v80
    v_add_f32 v73, v73, v81
    v_add_f32 v74, v74, v82
    v_add_f32 v75, v75, v83
    v_add_f32 v76, v76, v84
    v_add_f32 v77, v77, v85
    v_add_f32 v78, v78, v86
    v_add_f32 v79, v79, v87
    s_waitcnt lgkmcnt(0)
    v_add_f32 v88, v88, v96
    v_add_f32 v89, v89, v97
    v_add_f32 v90, v90, v98
    v_add_f32 v91, v91, v99
    v_add_f32 v92, v92, v100
    v_add_f32 v93, v93, v101
    v_add_f32 v94, v94, v102
    v_add_f32 v95, v95, v103
    v_add_f32 v72, v72, v88
    v_add_f32 v73, v73, v89
    v_add_f32 v74, v74, v90
    v_add_f32 v75, v75, v91
    v_add_f32 v76, v76, v92
    v_add_f32 v77, v77, v93
    v_add_f32 v78, v78, v94
    v_add_f32 v79, v79, v95
    v_cvt_pk_bf16_f32 v80, v72, v73
    v_cvt_pk_bf16_f32 v81, v74, v75
    v_cvt_pk_bf16_f32 v82, v76, v77
    v_cvt_pk_bf16_f32 v83, v78, v79
    v_lshlrev_b32 v72, 16, v80
    v_and_b32 v73, 0xffff0000, v80
    v_lshlrev_b32 v74, 16, v81
    v_and_b32 v75, 0xffff0000, v81
    v_lshlrev_b32 v76, 16, v82
    v_and_b32 v77, 0xffff0000, v82
    v_lshlrev_b32 v78, 16, v83
    v_and_b32 v79, 0xffff0000, v83
    v_mul_f32 v80, 0xbfb8aa3b, v72
    v_mul_f32 v81, 0xbfb8aa3b, v73
    v_mul_f32 v82, 0xbfb8aa3b, v74
    v_mul_f32 v83, 0xbfb8aa3b, v75
    v_mul_f32 v84, 0xbfb8aa3b, v76
    v_mul_f32 v85, 0xbfb8aa3b, v77
    v_mul_f32 v86, 0xbfb8aa3b, v78
    v_mul_f32 v87, 0xbfb8aa3b, v79
    v_exp_f32 v80, v80
    v_exp_f32 v81, v81
    v_exp_f32 v82, v82
    v_exp_f32 v83, v83
    v_exp_f32 v84, v84
    v_exp_f32 v85, v85
    v_exp_f32 v86, v86
    v_exp_f32 v87, v87
    v_add_f32 v80, 1.0, v80
    v_add_f32 v81, 1.0, v81
    v_add_f32 v82, 1.0, v82
    v_add_f32 v83, 1.0, v83
    v_add_f32 v84, 1.0, v84
    v_add_f32 v85, 1.0, v85
    v_add_f32 v86, 1.0, v86
    v_add_f32 v87, 1.0, v87
    v_rcp_f32 v80, v80
    v_rcp_f32 v81, v81
    v_rcp_f32 v82, v82
    v_rcp_f32 v83, v83
    v_rcp_f32 v84, v84
    v_rcp_f32 v85, v85
    v_rcp_f32 v86, v86
    v_rcp_f32 v87, v87
    v_mul_f32 v72, v72, v80
    v_mul_f32 v73, v73, v81
    v_mul_f32 v74, v74, v82
    v_mul_f32 v75, v75, v83
    v_mul_f32 v76, v76, v84
    v_mul_f32 v77, v77, v85
    v_mul_f32 v78, v78, v86
    v_mul_f32 v79, v79, v87
    v_cvt_pk_bf16_f32 v156, v72, v73
    v_cvt_pk_bf16_f32 v157, v74, v75
    v_cvt_pk_bf16_f32 v158, v76, v77
    v_cvt_pk_bf16_f32 v159, v78, v79
F_ghave:
    v_lshlrev_b32 v8, 16, v156
    v_and_b32 v9, 0xffff0000, v156
    v_lshlrev_b32 v16, 16, v152
    v_and_b32 v17, 0xffff0000, v152
    v_lshlrev_b32 v10, 16, v157
    v_and_b32 v11, 0xffff0000, v157
    v_lshlrev_b32 v18, 16, v153
    v_and_b32 v19, 0xffff0000, v153
    v_lshlrev_b32 v12, 16, v158
    v_and_b32 v13, 0xffff0000, v158
    v_lshlrev_b32 v20, 16, v154
    v_and_b32 v21, 0xffff0000, v154
    v_lshlrev_b32 v14, 16, v159
    v_and_b32 v15, 0xffff0000, v159
    v_lshlrev_b32 v22, 16, v155
    v_and_b32 v23, 0xffff0000, v155
Lw15:
    ds_read_b32 v162, v164 offset:160
    s_waitcnt lgkmcnt(0)
    v_readfirstlane_b32 s33, v162
    s_cmp_ge_u32 s33, 1
    s_cbranch_scc1 Lw15x
    s_branch Lw15
Lw15x:
    ds_read_b128 v[24:27], v5
    ds_read_b128 v[28:31], v5 offset:1024
    s_waitcnt lgkmcnt(0)
    v_add_f32 v136, v136, v24
    v_add_f32 v137, v137, v25
    v_add_f32 v138, v138, v26
    v_add_f32 v139, v139, v27
    v_add_f32 v140, v140, v28
    v_add_f32 v141, v141, v29
    v_add_f32 v142, v142, v30
    v_add_f32 v143, v143, v31
    v_cvt_pk_bf16_f32 v24, v136, v137
    v_cvt_pk_bf16_f32 v25, v138, v139
    v_cvt_pk_bf16_f32 v26, v140, v141
    v_cvt_pk_bf16_f32 v27, v142, v143
    s_nop 1
    v_permlane32_swap_b32 v24, v26
    v_permlane32_swap_b32 v25, v27
    s_nop 1
    v_lshlrev_b32 v32, 16, v24
    v_and_b32 v33, 0xffff0000, v24
    v_lshlrev_b32 v34, 16, v25
    v_and_b32 v35, 0xffff0000, v25
    v_lshlrev_b32 v36, 16, v26
    v_and_b32 v37, 0xffff0000, v26
    v_lshlrev_b32 v38, 16, v27
    v_and_b32 v39, 0xffff0000, v27
    v_mul_f32 v32, v32, v8
    v_mul_f32 v33, v33, v9
    v_mul_f32 v34, v34, v10
    v_mul_f32 v35, v35, v11
    v_mul_f32 v36, v36, v12
    v_mul_f32 v37, v37, v13
    v_mul_f32 v38, v38, v14
    v_mul_f32 v39, v39, v15
    v_cvt_pk_bf16_f32 v24, v32, v33
    v_cvt_pk_bf16_f32 v25, v34, v35
    v_cvt_pk_bf16_f32 v26, v36, v37
    v_cvt_pk_bf16_f32 v27, v38, v39
    v_lshlrev_b32 v32, 16, v24
    v_and_b32 v33, 0xffff0000, v24
    v_lshlrev_b32 v34, 16, v25
    v_and_b32 v35, 0xffff0000, v25
    v_lshlrev_b32 v36, 16, v26
    v_and_b32 v37, 0xffff0000, v26
    v_lshlrev_b32 v38, 16, v27
    v_and_b32 v39, 0xffff0000, v27
    v_add_f32 v32, v32, v16
    v_add_f32 v33, v33, v17
    v_add_f32 v34, v34, v18
    v_add_f32 v35, v35, v19
    v_add_f32 v36, v36, v20
    v_add_f32 v37, v37, v21
    v_add_f32 v38, v38, v22
    v_add_f32 v39, v39, v23
    v_cvt_pk_bf16_f32 v24, v32, v33
    v_cvt_pk_bf16_f32 v25, v34, v35
    v_cvt_pk_bf16_f32 v26, v36, v37
    v_cvt_pk_bf16_f32 v27, v38, v39
    buffer_store_dwordx4 v[24:27], v6, s[12:15], s30 offen
    s_branch F_end
F_awo:
    s_add_u32 m0, s27, s33
    s_nop 0
    buffer_load_dwordx4 v131, s[76:79], s66 offen lds
    s_add_u32 m0, m0, 1024
    s_nop 0
    buffer_load_dwordx4 v132, s[76:79], s66 offen lds
    s_add_u32 s66, s66, 65536
    s_branch F_awo_ret
F_aspin:
    s_sleep 1
    ds_read_b32 v116, v117 offset:128
    s_waitcnt lgkmcnt(0)
    v_cmp_gt_u32 vcc, s31, v116
    s_nop 1
    s_and_b32 s29, vcc_lo, s63
    s_cbranch_scc1 F_aspin
    s_branch F_aspin_ret
F_aslow:
    s_waitcnt vmcnt(0) lgkmcnt(0)
    v_mov_b32 v6, 0xff800000
    s_mov_b32 s28, s26
    s_mov_b32 s34, 64
F_smax:
    buffer_load_dwordx4 v[96:99], v2, s[20:23], s28 offen sc1
    s_waitcnt vmcnt(0)
    v_mfma_f32_32x32x16_bf16 v[32:47], v[96:99], v[8:11], 0
    s_add_u32 s28, s28, 2048
    s_sub_u32 s34, s34, 1
    s_nop 7
    s_nop 1
    v_max3_f32 v6, v6, v32, v33
    v_max3_f32 v6, v6, v34, v35
    v_max3_f32 v6, v6, v36, v37
    v_max3_f32 v6, v6, v38, v39
    v_max3_f32 v6, v6, v40, v41
    v_max3_f32 v6, v6, v42, v43
    v_max3_f32 v6, v6, v44, v45
    v_max3_f32 v6, v6, v46, v47
    s_cmp_lg_u32 s34, 0
    s_cbranch_scc1 F_smax
    v_mov_b32 v4, v6
    s_nop 1
    v_permlane32_swap_b32 v4, v6
    s_nop 1
    v_max_f32 v6, v4, v6
    v_sub_f32 v6, 0, v6
    v_mov_b32 v16, v6
    v_mov_b32 v17, v6
    v_mov_b32 v18, v6
    v_mov_b32 v19, v6
    v_mov_b32 v20, v6
    v_mov_b32 v21, v6
    v_mov_b32 v22, v6
    v_mov_b32 v23, v6
    v_mov_b32 v24, v6
    v_mov_b32 v25, v6
    v_mov_b32 v26, v6
    v_mov_b32 v27, v6
    v_mov_b32 v28, v6
    v_mov_b32 v29, v6
    v_mov_b32 v30, v6
    v_mov_b32 v31, v6
    v_mov_b32 v80, 0
    v_mov_b32 v81, 0
    v_mov_b32 v82, 0
    v_mov_b32 v83, 0
    v_mov_b32 v84, 0
    v_mov_b32 v85, 0
    v_mov_b32 v86, 0
    v_mov_b32 v87, 0
    v_mov_b32 v88, 0
    v_mov_b32 v89, 0
    v_mov_b32 v90, 0
    v_mov_b32 v91, 0
    v_mov_b32 v92, 0
    v_mov_b32 v93, 0
    v_mov_b32 v94, 0
    v_mov_b32 v95, 0
    s_mov_b32 s28, s26
    s_mov_b32 s34, 64
F_sloop:
    buffer_load_dwordx4 v[96:99], v2, s[20:23], s28 offen sc1
    s_mov_b64 exec, s[24:25]
    buffer_load_dwordx4 v[100:103], v3, s[20:23], s28 offen offset:1024 sc1
    buffer_load_dwordx4 v[104:107], v3, s[20:23], s28 offen offset:1536 sc1
    s_mov_b64 exec, -1
    s_waitcnt vmcnt(0)
    v_mfma_f32_32x32x16_bf16 v[32:47], v[96:99], v[8:11], v[16:31]
    s_add_u32 s28, s28, 2048
    s_sub_u32 s34, s34, 1
    s_nop 7
    s_nop 1
    v_exp_f32 v32, v32
    v_exp_f32 v33, v33
    v_exp_f32 v34, v34
    v_exp_f32 v35, v35
    v_exp_f32 v36, v36
    v_exp_f32 v37, v37
    v_exp_f32 v38, v38
    v_exp_f32 v39, v39
    v_exp_f32 v40, v40
    v_exp_f32 v41, v41
    v_exp_f32 v42, v42
    v_exp_f32 v43, v43
    v_exp_f32 v44, v44
    v_exp_f32 v45, v45
    v_exp_f32 v46, v46
    v_exp_f32 v47, v47
    s_nop 0
    v_cvt_pk_bf16_f32 v64, v32, v33
    v_cvt_pk_bf16_f32 v65, v34, v35
    v_cvt_pk_bf16_f32 v66, v36, v37
    v_cvt_pk_bf16_f32 v67, v38, v39
    v_cvt_pk_bf16_f32 v68, v40, v41
    v_cvt_pk_bf16_f32 v69, v42, v43
    v_cvt_pk_bf16_f32 v70, v44, v45
    v_cvt_pk_bf16_f32 v71, v46, v47
    s_nop 1
    v_mfma_f32_32x32x16_bf16 v[80:95], v[100:103], v[64:67], v[80:95]
    v_mfma_f32_32x32x16_bf16 v[80:95], v[104:107], v[68:71], v[80:95]
    s_cmp_lg_u32 s34, 0
    s_cbranch_scc1 F_sloop
    s_nop 7
    s_nop 3
    s_branch F_astore
F_lb:
    s_setprio 2
    s_sub_u32 s3, s3, 8
    v_lshlrev_b32 v7, 2, v0
    v_mov_b32 v1, 0
    ds_write_b32 v7, v1
    v_lshlrev_b32 v7, 4, v0
    s_bfe_u32 s24, s2, 0x20001
    s_lshl_b32 s24, s24, 2
    s_lshr_b32 s25, s2, 6
    s_add_u32 s24, s24, s25
    s_and_b32 s25, s2, 1
    s_lshl_b32 s25, s25, 3
    s_bfe_u32 s26, s2, 0x30003
    s_add_u32 s25, s25, s26
    v_lshrrev_b32 v4, 3, v0
    v_and_b32 v5, 7, v0
    v_lshrrev_b32 v6, 4, v0
    v_xor_b32 v5, v5, v6
    v_xor_b32 v8, 4, v5
    s_lshl_b32 s28, s3, 15
    v_lshlrev_b32 v4, 10, v4
    v_add_u32 v4, s28, v4
    v_lshl_add_u32 v60, v5, 4, v4
    v_lshl_add_u32 v61, v8, 4, v4
    v_add_u32 v61, 8192, v61
    v_add_u32 v62, 16384, v60
    v_add_u32 v63, 16384, v61
    v_lshrrev_b32 v4, 2, v0
    s_lshl_b32 s28, s3, 4
    v_add_u32 v4, s28, v4
    v_mul_u32_u24 v4, 3072, v4
    v_and_b32 v5, 3, v0
    v_lshl_add_u32 v64, v5, 4, v4
    s_lshl_b32 s28, s25, 6
    v_add_u32 v64, s28, v64
    v_add_u32 v65, 1024, v64
    v_add_u32 v66, 2048, v64
    s_lshl_b32 s70, s24, 1
    s_add_u32 s70, s70, s25
    s_and_b32 s70, s70, 7
    s_lshl_b32 s71, s24, 17
    s_lshl_b32 s72, s3, 12
    s_add_u32 s72, s72, 768
    s_lshl_b32 s73, s3, 10
    s_add_u32 s73, s73, 17152
    s_mov_b32 s74, 57344
    s_waitcnt lgkmcnt(0)
    s_barrier
    s_mov_b32 s60, s4
    s_mov_b32 s61, s5
    s_mov_b32 s62, 2097152
    s_mov_b32 s63, 0x00020000
    s_mov_b32 s64, s6
    s_mov_b32 s65, s7
    s_mov_b32 s66, 1572864
    s_mov_b32 s67, 0x00020000
    s_mov_b32 s20, s16
    s_mov_b32 s21, s17
    s_mov_b32 s22, 33554432
    s_mov_b32 s23, 0x00020000
    s_mov_b32 s52, s18
    s_mov_b32 s53, s19
    s_mov_b32 s54, 256
    s_mov_b32 s55, 0x00020000
    s_mov_b32 s79, 0
F_lpro:
    s_lshl_b32 s75, s70, 7
    s_add_u32 s75, s75, s71
    s_mul_i32 s76, s70, 196608
    s_add_u32 s70, s70, 1
    s_and_b32 s70, s70, 7
    s_add_u32 s77, s72, s74
    s_add_u32 s78, s73, s74
    s_add_u32 m0, s77, 0
    s_nop 0
    buffer_load_dwordx4 v60, s[60:63], s75 offen lds
    s_add_u32 m0, s77, 1024
    s_nop 0
    buffer_load_dwordx4 v61, s[60:63], s75 offen lds
    s_add_u32 m0, s77, 2048
    s_nop 0
    buffer_load_dwordx4 v62, s[60:63], s75 offen lds
    s_add_u32 m0, s77, 3072
    s_nop 0
    buffer_load_dwordx4 v63, s[60:63], s75 offen lds
    s_add_u32 m0, s78, 0
    s_nop 0
    buffer_load_dwordx4 v64, s[64:67], s76 offen lds
    s_add_u32 m0, s78, 4096
    s_nop 0
    buffer_load_dwordx4 v65, s[64:67], s76 offen lds
    s_add_u32 m0, s78, 8192
    s_nop 0
    buffer_load_dwordx4 v66, s[64:67], s76 offen lds
    s_add_u32 s74, s74, 28672
    s_cmp_eq_u32 s74, 143360
    s_cselect_b32 s74, 0, s74
    s_add_u32 s79, s79, 1
    s_cmp_lt_u32 s79, 2
    s_cbranch_scc1 F_lpro
    s_mov_b32 s4, s48
    s_mov_b32 s5, s49
    s_mov_b32 s6, s50
    s_mov_b32 s7, s51
    s_and_b32 s24, s2, 1
    s_lshl_b32 s24, s24, 3
    s_bfe_u32 s25, s2, 0x30003
    s_add_u32 s24, s24, s25
    s_bfe_u32 s25, s2, 0x20001
    s_lshl_b32 s25, s25, 2
    s_lshr_b32 s26, s2, 6
    s_add_u32 s25, s25, s26
    s_cmp_lt_u32 s3, 2
    s_cselect_b32 s8, s4, s6
    s_cselect_b32 s9, s5, s7
    s_mov_b32 s10, 1835008
    s_mov_b32 s11, 0x00020000
    s_and_b32 s26, s3, 1
    s_mul_i32 s27, s26, 448
    s_mul_i32 s28, s25, 224
    s_mov_b32 s29, 18725
    v_add_u32 v12, 0, v0
    v_add_u32 v12, s27, v12
    v_mul_u32_u24 v13, s29, v12
    v_lshrrev_b32 v13, 18, v13
    v_mul_u32_u24 v14, 14, v13
    v_sub_u32 v14, v12, v14
    v_mul_u32_u24 v13, 3584, v13
    v_lshl_add_u32 v13, v14, 4, v13
    v_add_u32 v2, s28, v13
    v_add_u32 v12, 64, v0
    v_add_u32 v12, s27, v12
    v_mul_u32_u24 v13, s29, v12
    v_lshrrev_b32 v13, 18, v13
    v_mul_u32_u24 v14, 14, v13
    v_sub_u32 v14, v12, v14
    v_mul_u32_u24 v13, 3584, v13
    v_lshl_add_u32 v13, v14, 4, v13
    v_add_u32 v3, s28, v13
    v_add_u32 v12, 128, v0
    v_add_u32 v12, s27, v12
    v_mul_u32_u24 v13, s29, v12
    v_lshrrev_b32 v13, 18, v13
    v_mul_u32_u24 v14, 14, v13
    v_sub_u32 v14, v12, v14
    v_mul_u32_u24 v13, 3584, v13
    v_lshl_add_u32 v13, v14, 4, v13
    v_add_u32 v4, s28, v13
    v_add_u32 v12, 192, v0
    v_add_u32 v12, s27, v12
    v_mul_u32_u24 v13, s29, v12
    v_lshrrev_b32 v13, 18, v13
    v_mul_u32_u24 v14, 14, v13
    v_sub_u32 v14, v12, v14
    v_mul_u32_u24 v13, 3584, v13
    v_lshl_add_u32 v13, v14, 4, v13
    v_add_u32 v5, s28, v13
    v_add_u32 v12, 256, v0
    v_add_u32 v12, s27, v12
    v_mul_u32_u24 v13, s29, v12
    v_lshrrev_b32 v13, 18, v13
    v_mul_u32_u24 v14, 14, v13
    v_sub_u32 v14, v12, v14
    v_mul_u32_u24 v13, 3584, v13
    v_lshl_add_u32 v13, v14, 4, v13
    v_add_u32 v6, s28, v13
    v_add_u32 v12, 320, v0
    v_add_u32 v12, s27, v12
    v_mul_u32_u24 v13, s29, v12
    v_lshrrev_b32 v13, 18, v13
    v_mul_u32_u24 v14, 14, v13
    v_sub_u32 v14, v12, v14
    v_mul_u32_u24 v13, 3584, v13
    v_lshl_add_u32 v13, v14, 4, v13
    v_add_u32 v8, s28, v13
    v_add_u32 v12, 384, v0
    v_add_u32 v12, s27, v12
    v_mul_u32_u24 v13, s29, v12
    v_lshrrev_b32 v13, 18, v13
    v_mul_u32_u24 v14, 14, v13
    v_sub_u32 v14, v12, v14
    v_mul_u32_u24 v13, 3584, v13
    v_lshl_add_u32 v13, v14, 4, v13
    v_add_u32 v9, s28, v13
    s_mul_i32 s27, s26, 7168
    s_lshr_b32 s26, s3, 1
    s_mul_i32 s26, s26, 14464
    s_add_u32 s27, s27, s26
    s_add_u32 s27, s27, 256
    s_lshl_b32 s30, s25, 1
    s_add_u32 s30, s30, s24
    s_and_b32 s30, s30, 7
    s_mov_b32 s31, s30
    s_lshl_b32 s32, s24, 2
    s_add_u32 s32, s32, s3
    s_lshl_b32 s33, s32, 15
    s_add_u32 s33, s33, 25165824
    v_lshlrev_b32 v7, 4, v0
    v_lshrrev_b32 v12, 5, v0
    v_bfe_u32 v13, v0, 2, 2
    v_lshl_add_u32 v12, v12, 3, v13
    v_mul_u32_u24 v12, 224, v12
    v_bfe_u32 v13, v0, 4, 1
    v_mul_u32_u24 v13, 14464, v13
    v_add_u32 v12, v12, v13
    v_and_b32 v13, 3, v0
    v_lshl_add_u32 v10, v13, 3, v12
    v_add_u32 v10, 256, v10
    v_add_u32 v11, 57856, v10
    s_lshl_b32 s36, s24, 11
    s_add_u32 s36, s36, 31457280
    v_and_b32 v1, 15, v0
    v_lshlrev_b32 v1, 7, v1
    v_mov_b32 v67, 0
    s_and_b32 s37, s24, 7
    s_lshl_b32 s37, s37, 1
    s_and_b32 s38, s3, 1
    s_add_u32 s37, s37, s38
    s_lshl_b32 s37, s37, 5
    v_and_b32 v68, 31, v0
    v_add_u32 v68, s37, v68
    v_mul_u32_u24 v68, 3584, v68
    v_add_u32 v68, s28, v68
    v_lshrrev_b32 v69, 5, v0
    v_lshl_add_u32 v69, v69, 7, v68
    s_waitcnt vmcnt(7)
    s_barrier
    s_lshl_b32 s75, s70, 7
    s_add_u32 s75, s75, s71
    s_mul_i32 s76, s70, 196608
    s_add_u32 s70, s70, 1
    s_and_b32 s70, s70, 7
    s_add_u32 s77, s72, s74
    s_add_u32 s78, s73, s74
    s_add_u32 m0, s77, 0
    s_nop 0
    buffer_load_dwordx4 v60, s[60:63], s75 offen lds
    s_add_u32 m0, s77, 1024
    s_nop 0
    buffer_load_dwordx4 v61, s[60:63], s75 offen lds
    s_add_u32 m0, s77, 2048
    s_nop 0
    buffer_load_dwordx4 v62, s[60:63], s75 offen lds
    s_add_u32 m0, s77, 3072
    s_nop 0
    buffer_load_dwordx4 v63, s[60:63], s75 offen lds
    s_add_u32 m0, s78, 0
    s_nop 0
    buffer_load_dwordx4 v64, s[64:67], s76 offen lds
    s_add_u32 m0, s78, 4096
    s_nop 0
    buffer_load_dwordx4 v65, s[64:67], s76 offen lds
    s_add_u32 m0, s78, 8192
    s_nop 0
    buffer_load_dwordx4 v66, s[64:67], s76 offen lds
    s_add_u32 s74, s74, 28672
    s_cmp_eq_u32 s74, 143360
    s_cselect_b32 s74, 0, s74
    s_waitcnt vmcnt(7)
    s_barrier
    s_lshl_b32 s75, s70, 7
    s_add_u32 s75, s75, s71
    s_mul_i32 s76, s70, 196608
    s_add_u32 s70, s70, 1
    s_and_b32 s70, s70, 7
    s_add_u32 s77, s72, s74
    s_add_u32 s78, s73, s74
    s_add_u32 m0, s77, 0
    s_nop 0
    buffer_load_dwordx4 v60, s[60:63], s75 offen lds
    s_add_u32 m0, s77, 1024
    s_nop 0
    buffer_load_dwordx4 v61, s[60:63], s75 offen lds
    s_add_u32 m0, s77, 2048
    s_nop 0
    buffer_load_dwordx4 v62, s[60:63], s75 offen lds
    s_add_u32 m0, s77, 3072
    s_nop 0
    buffer_load_dwordx4 v63, s[60:63], s75 offen lds
    s_add_u32 m0, s78, 0
    s_nop 0
    buffer_load_dwordx4 v64, s[64:67], s76 offen lds
    s_add_u32 m0, s78, 4096
    s_nop 0
    buffer_load_dwordx4 v65, s[64:67], s76 offen lds
    s_add_u32 m0, s78, 8192
    s_nop 0
    buffer_load_dwordx4 v66, s[64:67], s76 offen lds
    s_add_u32 s74, s74, 28672
    s_cmp_eq_u32 s74, 143360
    s_cselect_b32 s74, 0, s74
    s_waitcnt vmcnt(7)
    s_barrier
    s_lshl_b32 s75, s70, 7
    s_add_u32 s75, s75, s71
    s_mul_i32 s76, s70, 196608
    s_add_u32 s70, s70, 1
    s_and_b32 s70, s70, 7
    s_add_u32 s77, s72, s74
    s_add_u32 s78, s73, s74
    s_add_u32 m0, s77, 0
    s_nop 0
    buffer_load_dwordx4 v60, s[60:63], s75 offen lds
    s_add_u32 m0, s77, 1024
    s_nop 0
    buffer_load_dwordx4 v61, s[60:63], s75 offen lds
    s_add_u32 m0, s77, 2048
    s_nop 0
    buffer_load_dwordx4 v62, s[60:63], s75 offen lds
    s_add_u32 m0, s77, 3072
    s_nop 0
    buffer_load_dwordx4 v63, s[60:63], s75 offen lds
    s_add_u32 m0, s78, 0
    s_nop 0
    buffer_load_dwordx4 v64, s[64:67], s76 offen lds
    s_add_u32 m0, s78, 4096
    s_nop 0
    buffer_load_dwordx4 v65, s[64:67], s76 offen lds
    s_add_u32 m0, s78, 8192
    s_nop 0
    buffer_load_dwordx4 v66, s[64:67], s76 offen lds
    s_add_u32 s74, s74, 28672
    s_cmp_eq_u32 s74, 143360
    s_cselect_b32 s74, 0, s74
    s_waitcnt vmcnt(7)
    s_barrier
    s_lshl_b32 s75, s70, 7
    s_add_u32 s75, s75, s71
    s_mul_i32 s76, s70, 196608
    s_add_u32 s70, s70, 1
    s_and_b32 s70, s70, 7
    s_add_u32 s77, s72, s74
    s_add_u32 s78, s73, s74
    s_add_u32 m0, s77, 0
    s_nop 0
    buffer_load_dwordx4 v60, s[60:63], s75 offen lds
    s_add_u32 m0, s77, 1024
    s_nop 0
    buffer_load_dwordx4 v61, s[60:63], s75 offen lds
    s_add_u32 m0, s77, 2048
    s_nop 0
    buffer_load_dwordx4 v62, s[60:63], s75 offen lds
    s_add_u32 m0, s77, 3072
    s_nop 0
    buffer_load_dwordx4 v63, s[60:63], s75 offen lds
    s_add_u32 m0, s78, 0
    s_nop 0
    buffer_load_dwordx4 v64, s[64:67], s76 offen lds
    s_add_u32 m0, s78, 4096
    s_nop 0
    buffer_load_dwordx4 v65, s[64:67], s76 offen lds
    s_add_u32 m0, s78, 8192
    s_nop 0
    buffer_load_dwordx4 v66, s[64:67], s76 offen lds
    s_add_u32 s74, s74, 28672
    s_cmp_eq_u32 s74, 143360
    s_cselect_b32 s74, 0, s74
    s_waitcnt vmcnt(7)
    s_barrier
    s_lshl_b32 s75, s70, 7
    s_add_u32 s75, s75, s71
    s_mul_i32 s76, s70, 196608
    s_add_u32 s70, s70, 1
    s_and_b32 s70, s70, 7
    s_add_u32 s77, s72, s74
    s_add_u32 s78, s73, s74
    s_add_u32 m0, s77, 0
    s_nop 0
    buffer_load_dwordx4 v60, s[60:63], s75 offen lds
    s_add_u32 m0, s77, 1024
    s_nop 0
    buffer_load_dwordx4 v61, s[60:63], s75 offen lds
    s_add_u32 m0, s77, 2048
    s_nop 0
    buffer_load_dwordx4 v62, s[60:63], s75 offen lds
    s_add_u32 m0, s77, 3072
    s_nop 0
    buffer_load_dwordx4 v63, s[60:63], s75 offen lds
    s_add_u32 m0, s78, 0
    s_nop 0
    buffer_load_dwordx4 v64, s[64:67], s76 offen lds
    s_add_u32 m0, s78, 4096
    s_nop 0
    buffer_load_dwordx4 v65, s[64:67], s76 offen lds
    s_add_u32 m0, s78, 8192
    s_nop 0
    buffer_load_dwordx4 v66, s[64:67], s76 offen lds
    s_add_u32 s74, s74, 28672
    s_cmp_eq_u32 s74, 143360
    s_cselect_b32 s74, 0, s74
    s_waitcnt vmcnt(7)
    s_barrier
    s_lshl_b32 s75, s70, 7
    s_add_u32 s75, s75, s71
    s_mul_i32 s76, s70, 196608
    s_add_u32 s70, s70, 1
    s_and_b32 s70, s70, 7
    s_add_u32 s77, s72, s74
    s_add_u32 s78, s73, s74
    s_add_u32 m0, s77, 0
    s_nop 0
    buffer_load_dwordx4 v60, s[60:63], s75 offen lds
    s_add_u32 m0, s77, 1024
    s_nop 0
    buffer_load_dwordx4 v61, s[60:63], s75 offen lds
    s_add_u32 m0, s77, 2048
    s_nop 0
    buffer_load_dwordx4 v62, s[60:63], s75 offen lds
    s_add_u32 m0, s77, 3072
    s_nop 0
    buffer_load_dwordx4 v63, s[60:63], s75 offen lds
    s_add_u32 m0, s78, 0
    s_nop 0
    buffer_load_dwordx4 v64, s[64:67], s76 offen lds
    s_add_u32 m0, s78, 4096
    s_nop 0
    buffer_load_dwordx4 v65, s[64:67], s76 offen lds
    s_add_u32 m0, s78, 8192
    s_nop 0
    buffer_load_dwordx4 v66, s[64:67], s76 offen lds
    s_add_u32 s74, s74, 28672
    s_cmp_eq_u32 s74, 143360
    s_cselect_b32 s74, 0, s74
    s_waitcnt vmcnt(7)
    s_barrier
    buffer_load_dwordx2 v[12:13], v67, s[52:55], 0 offen sc1
    buffer_load_dwordx2 v[14:15], v1, s[20:23], s36 offen sc1
    s_mul_i32 s34, s30, 229376
    s_add_u32 s30, s30, 1
    s_and_b32 s30, s30, 7
    s_add_u32 m0, s27, 0
    s_nop 0
    buffer_load_dwordx4 v2, s[8:11], s34 offen lds
    s_add_u32 m0, s27, 1024
    s_nop 0
    buffer_load_dwordx4 v3, s[8:11], s34 offen lds
    s_add_u32 m0, s27, 2048
    s_nop 0
    buffer_load_dwordx4 v4, s[8:11], s34 offen lds
    s_add_u32 m0, s27, 3072
    s_nop 0
    buffer_load_dwordx4 v5, s[8:11], s34 offen lds
    s_add_u32 m0, s27, 4096
    s_nop 0
    buffer_load_dwordx4 v6, s[8:11], s34 offen lds
    s_add_u32 m0, s27, 5120
    s_nop 0
    buffer_load_dwordx4 v8, s[8:11], s34 offen lds
    s_add_u32 m0, s27, 6144
    s_nop 0
    buffer_load_dwordx4 v9, s[8:11], s34 offen lds
    s_waitcnt vmcnt(9)
    s_barrier
    s_waitcnt vmcnt(7)
    v_readfirstlane_b32 s68, v12
    v_readfirstlane_b32 s69, v13
    v_cmp_ne_u64 vcc, v[12:13], v[14:15]
    s_cmp_eq_u32 s68, 0
    s_cbranch_scc1 F_xslow
    s_cmp_eq_u64 vcc, 0
    s_cbranch_scc1 F_xok
F_xslow:
Lr16:
    buffer_load_dwordx2 v[12:13], v67, s[52:55], 0 offen sc1
    s_waitcnt vmcnt(0)
    v_readfirstlane_b32 s68, v12
    v_readfirstlane_b32 s69, v13
    s_cmp_eq_u32 s68, 0
    s_cbranch_scc1 Lr16
Lq17:
    buffer_load_dwordx2 v[12:13], v1, s[20:23], s36 offen sc1
    s_waitcnt vmcnt(0)
    v_cmp_ne_u64 vcc, s[68:69], v[12:13]
    s_nop 1
    s_cmp_eq_u64 vcc, 0
    s_cbranch_scc1 Lq17x
    s_sleep 1
    s_branch Lq17
Lq17x:
F_xok:
    s_lshl_b32 s35, s31, 12
    s_add_u32 s35, s35, s33
    s_add_u32 s31, s31, 1
    s_and_b32 s31, s31, 7
    buffer_load_dwordx4 v[12:15], v7, s[20:23], s35 offen offset:0 sc1
    buffer_load_dwordx4 v[16:19], v7, s[20:23], s35 offen offset:1024 sc1
    buffer_load_dwordx4 v[20:23], v7, s[20:23], s35 offen offset:2048 sc1
    buffer_load_dwordx4 v[24:27], v7, s[20:23], s35 offen offset:3072 sc1
    s_mul_i32 s34, s30, 229376
    s_add_u32 s30, s30, 1
    s_and_b32 s30, s30, 7
    s_add_u32 m0, s27, 28928
    s_nop 0
    buffer_load_dwordx4 v2, s[8:11], s34 offen lds
    s_add_u32 m0, s27, 29952
    s_nop 0
    buffer_load_dwordx4 v3, s[8:11], s34 offen lds
    s_add_u32 m0, s27, 30976
    s_nop 0
    buffer_load_dwordx4 v4, s[8:11], s34 offen lds
    s_add_u32 m0, s27, 32000
    s_nop 0
    buffer_load_dwordx4 v5, s[8:11], s34 offen lds
    s_add_u32 m0, s27, 33024
    s_nop 0
    buffer_load_dwordx4 v6, s[8:11], s34 offen lds
    s_add_u32 m0, s27, 34048
    s_nop 0
    buffer_load_dwordx4 v8, s[8:11], s34 offen lds
    s_add_u32 m0, s27, 35072
    s_nop 0
    buffer_load_dwordx4 v9, s[8:11], s34 offen lds
    s_waitcnt vmcnt(11)
    s_mov_b64 exec, 2
    ds_add_u32 v7, v7 offset:64
    s_mov_b64 exec, 1
F_bb1:
    ds_read_b32 v1, v7 offset:80
    s_waitcnt lgkmcnt(0)
    v_readfirstlane_b32 s56, v1
    s_cmp_ge_u32 s56, 64
    s_cbranch_scc0 F_bb1
    s_mov_b64 exec, -1
    ds_read_b64_tr_b16 v[28:29], v10 offset:0
    ds_read_b64_tr_b16 v[30:31], v10 offset:896
    ds_read_b64_tr_b16 v[32:33], v10 offset:32
    ds_read_b64_tr_b16 v[34:35], v10 offset:928
    ds_read_b64_tr_b16 v[36:37], v10 offset:64
    ds_read_b64_tr_b16 v[38:39], v10 offset:960
    ds_read_b64_tr_b16 v[40:41], v10 offset:96
    ds_read_b64_tr_b16 v[42:43], v10 offset:992
    ds_read_b64_tr_b16 v[44:45], v10 offset:128
    ds_read_b64_tr_b16 v[46:47], v10 offset:1024
    ds_read_b64_tr_b16 v[48:49], v10 offset:160
    ds_read_b64_tr_b16 v[50:51], v10 offset:1056
    ds_read_b64_tr_b16 v[52:53], v10 offset:192
    ds_read_b64_tr_b16 v[54:55], v10 offset:1088
    s_setprio 0
    s_waitcnt vmcnt(10)
    s_waitcnt lgkmcnt(12)
    v_mfma_f32_32x32x16_bf16 v[56:71], v[28:31], v[12:15], 0
    ds_read_b64_tr_b16 v[28:29], v10 offset:3584
    ds_read_b64_tr_b16 v[30:31], v10 offset:4480
    s_waitcnt lgkmcnt(12)
    v_mfma_f32_32x32x16_bf16 v[72:87], v[32:35], v[12:15], 0
    ds_read_b64_tr_b16 v[32:33], v10 offset:3616
    ds_read_b64_tr_b16 v[34:35], v10 offset:4512
    s_waitcnt lgkmcnt(12)
    v_mfma_f32_32x32x16_bf16 v[88:103], v[36:39], v[12:15], 0
    ds_read_b64_tr_b16 v[36:37], v10 offset:3648
    ds_read_b64_tr_b16 v[38:39], v10 offset:4544
    s_waitcnt lgkmcnt(12)
    v_mfma_f32_32x32x16_bf16 v[104:119], v[40:43], v[12:15], 0
    ds_read_b64_tr_b16 v[40:41], v10 offset:3680
    ds_read_b64_tr_b16 v[42:43], v10 offset:4576
    s_waitcnt lgkmcnt(12)
    v_mfma_f32_32x32x16_bf16 v[120:135], v[44:47], v[12:15], 0
    ds_read_b64_tr_b16 v[44:45], v10 offset:3712
    ds_read_b64_tr_b16 v[46:47], v10 offset:4608
    s_waitcnt lgkmcnt(12)
    v_mfma_f32_32x32x16_bf16 v[136:151], v[48:51], v[12:15], 0
    ds_read_b64_tr_b16 v[48:49], v10 offset:3744
    ds_read_b64_tr_b16 v[50:51], v10 offset:4640
    s_waitcnt lgkmcnt(12)
    v_mfma_f32_32x32x16_bf16 v[152:167], v[52:55], v[12:15], 0
    ds_read_b64_tr_b16 v[52:53], v10 offset:3776
    ds_read_b64_tr_b16 v[54:55], v10 offset:4672
    s_lshl_b32 s35, s31, 12
    s_add_u32 s35, s35, s33
    s_add_u32 s31, s31, 1
    s_and_b32 s31, s31, 7
    buffer_load_dwordx4 v[12:15], v7, s[20:23], s35 offen offset:0 sc1
    v_mov_b32 v0, 0
Lw18:
    ds_read_b32 v1, v0 offset:12
    s_waitcnt lgkmcnt(0)
    v_readfirstlane_b32 s37, v1
    s_cmp_ge_u32 s37, 8
    s_cbranch_scc1 Lw18x
    s_sleep 1
    s_branch Lw18
Lw18x:
    s_waitcnt vmcnt(10)
    v_mfma_f32_32x32x16_bf16 v[56:71], v[28:31], v[16:19], v[56:71]
    ds_read_b64_tr_b16 v[28:29], v10 offset:7168
    ds_read_b64_tr_b16 v[30:31], v10 offset:8064
    s_mul_i32 s34, s30, 229376
    s_add_u32 s30, s30, 1
    s_and_b32 s30, s30, 7
    s_add_u32 m0, s27, 57856
    s_nop 0
    buffer_load_dwordx4 v2, s[8:11], s34 offen lds
    v_mfma_f32_32x32x16_bf16 v[72:87], v[32:35], v[16:19], v[72:87]
    ds_read_b64_tr_b16 v[32:33], v10 offset:7200
    ds_read_b64_tr_b16 v[34:35], v10 offset:8096
    s_add_u32 m0, s27, 58880
    s_nop 0
    buffer_load_dwordx4 v3, s[8:11], s34 offen lds
    v_mfma_f32_32x32x16_bf16 v[88:103], v[36:39], v[16:19], v[88:103]
    ds_read_b64_tr_b16 v[36:37], v10 offset:7232
    ds_read_b64_tr_b16 v[38:39], v10 offset:8128
    s_add_u32 m0, s27, 59904
    s_nop 0
    buffer_load_dwordx4 v4, s[8:11], s34 offen lds
    v_mfma_f32_32x32x16_bf16 v[104:119], v[40:43], v[16:19], v[104:119]
    ds_read_b64_tr_b16 v[40:41], v10 offset:7264
    ds_read_b64_tr_b16 v[42:43], v10 offset:8160
    v_mfma_f32_32x32x16_bf16 v[120:135], v[44:47], v[16:19], v[120:135]
    ds_read_b64_tr_b16 v[44:45], v10 offset:7296
    ds_read_b64_tr_b16 v[46:47], v10 offset:8192
    s_add_u32 m0, s27, 60928
    s_nop 0
    buffer_load_dwordx4 v5, s[8:11], s34 offen lds
    v_mfma_f32_32x32x16_bf16 v[136:151], v[48:51], v[16:19], v[136:151]
    ds_read_b64_tr_b16 v[48:49], v10 offset:7328
    ds_read_b64_tr_b16 v[50:51], v10 offset:8224
    s_add_u32 m0, s27, 61952
    s_nop 0
    buffer_load_dwordx4 v6, s[8:11], s34 offen lds
    v_mfma_f32_32x32x16_bf16 v[152:167], v[52:55], v[16:19], v[152:167]
    ds_read_b64_tr_b16 v[52:53], v10 offset:7360
    ds_read_b64_tr_b16 v[54:55], v10 offset:8256
    s_add_u32 m0, s27, 62976
    s_nop 0
    buffer_load_dwordx4 v8, s[8:11], s34 offen lds
    buffer_load_dwordx4 v[16:19], v7, s[20:23], s35 offen offset:1024 sc1
    s_waitcnt vmcnt(16)
    s_waitcnt lgkmcnt(12)
    v_mfma_f32_32x32x16_bf16 v[56:71], v[28:31], v[20:23], v[56:71]
    ds_read_b64_tr_b16 v[28:29], v10 offset:10752
    ds_read_b64_tr_b16 v[30:31], v10 offset:11648
    s_add_u32 m0, s27, 64000
    s_nop 0
    buffer_load_dwordx4 v9, s[8:11], s34 offen lds
    s_waitcnt lgkmcnt(12)
    v_mfma_f32_32x32x16_bf16 v[72:87], v[32:35], v[20:23], v[72:87]
    ds_read_b64_tr_b16 v[32:33], v10 offset:10784
    ds_read_b64_tr_b16 v[34:35], v10 offset:11680
    s_waitcnt lgkmcnt(12)
    v_mfma_f32_32x32x16_bf16 v[88:103], v[36:39], v[20:23], v[88:103]
    ds_read_b64_tr_b16 v[36:37], v10 offset:10816
    ds_read_b64_tr_b16 v[38:39], v10 offset:11712
    s_waitcnt lgkmcnt(12)
    v_mfma_f32_32x32x16_bf16 v[104:119], v[40:43], v[20:23], v[104:119]
    ds_read_b64_tr_b16 v[40:41], v10 offset:10848
    ds_read_b64_tr_b16 v[42:43], v10 offset:11744
    s_waitcnt lgkmcnt(12)
    v_mfma_f32_32x32x16_bf16 v[120:135], v[44:47], v[20:23], v[120:135]
    ds_read_b64_tr_b16 v[44:45], v10 offset:10880
    ds_read_b64_tr_b16 v[46:47], v10 offset:11776
    s_waitcnt lgkmcnt(12)
    v_mfma_f32_32x32x16_bf16 v[136:151], v[48:51], v[20:23], v[136:151]
    ds_read_b64_tr_b16 v[48:49], v10 offset:10912
    ds_read_b64_tr_b16 v[50:51], v10 offset:11808
    s_waitcnt lgkmcnt(12)
    v_mfma_f32_32x32x16_bf16 v[152:167], v[52:55], v[20:23], v[152:167]
    ds_read_b64_tr_b16 v[52:53], v10 offset:10944
    ds_read_b64_tr_b16 v[54:55], v10 offset:11840
    buffer_load_dwordx4 v[20:23], v7, s[20:23], s35 offen offset:2048 sc1
    s_waitcnt vmcnt(10)
    s_setprio 2
    s_mov_b64 exec, 2
    ds_add_u32 v7, v7 offset:64
    s_mov_b64 exec, 1
F_bb2:
    ds_read_b32 v1, v7 offset:80
    s_waitcnt lgkmcnt(0)
    v_readfirstlane_b32 s56, v1
    s_cmp_ge_u32 s56, 128
    s_cbranch_scc0 F_bb2
    s_mov_b64 exec, -1
    s_setprio 0
    v_mfma_f32_32x32x16_bf16 v[56:71], v[28:31], v[24:27], v[56:71]
    ds_read_b64_tr_b16 v[28:29], v10 offset:28928
    ds_read_b64_tr_b16 v[30:31], v10 offset:29824
    s_mul_i32 s34, s30, 229376
    s_add_u32 s30, s30, 1
    s_and_b32 s30, s30, 7
    s_add_u32 m0, s27, 0
    s_nop 0
    buffer_load_dwordx4 v2, s[8:11], s34 offen lds
    v_mfma_f32_32x32x16_bf16 v[72:87], v[32:35], v[24:27], v[72:87]
    ds_read_b64_tr_b16 v[32:33], v10 offset:28960
    ds_read_b64_tr_b16 v[34:35], v10 offset:29856
    v_mfma_f32_32x32x16_bf16 v[88:103], v[36:39], v[24:27], v[88:103]
    ds_read_b64_tr_b16 v[36:37], v10 offset:28992
    ds_read_b64_tr_b16 v[38:39], v10 offset:29888
    s_add_u32 m0, s27, 1024
    s_nop 0
    buffer_load_dwordx4 v3, s[8:11], s34 offen lds
    v_mfma_f32_32x32x16_bf16 v[104:119], v[40:43], v[24:27], v[104:119]
    ds_read_b64_tr_b16 v[40:41], v10 offset:29024
    ds_read_b64_tr_b16 v[42:43], v10 offset:29920
    s_add_u32 m0, s27, 2048
    s_nop 0
    buffer_load_dwordx4 v4, s[8:11], s34 offen lds
    v_mfma_f32_32x32x16_bf16 v[120:135], v[44:47], v[24:27], v[120:135]
    ds_read_b64_tr_b16 v[44:45], v10 offset:29056
    ds_read_b64_tr_b16 v[46:47], v10 offset:29952
    s_add_u32 m0, s27, 3072
    s_nop 0
    buffer_load_dwordx4 v5, s[8:11], s34 offen lds
    v_mfma_f32_32x32x16_bf16 v[136:151], v[48:51], v[24:27], v[136:151]
    ds_read_b64_tr_b16 v[48:49], v10 offset:29088
    ds_read_b64_tr_b16 v[50:51], v10 offset:29984
    v_mfma_f32_32x32x16_bf16 v[152:167], v[52:55], v[24:27], v[152:167]
    ds_read_b64_tr_b16 v[52:53], v10 offset:29120
    ds_read_b64_tr_b16 v[54:55], v10 offset:30016
    s_add_u32 m0, s27, 4096
    s_nop 0
    buffer_load_dwordx4 v6, s[8:11], s34 offen lds
    buffer_load_dwordx4 v[24:27], v7, s[20:23], s35 offen offset:3072 sc1
    s_waitcnt vmcnt(15)
    s_waitcnt lgkmcnt(12)
    v_mfma_f32_32x32x16_bf16 v[56:71], v[28:31], v[12:15], v[56:71]
    ds_read_b64_tr_b16 v[28:29], v10 offset:32512
    ds_read_b64_tr_b16 v[30:31], v10 offset:33408
    s_add_u32 m0, s27, 5120
    s_nop 0
    buffer_load_dwordx4 v8, s[8:11], s34 offen lds
    s_waitcnt lgkmcnt(12)
    v_mfma_f32_32x32x16_bf16 v[72:87], v[32:35], v[12:15], v[72:87]
    ds_read_b64_tr_b16 v[32:33], v10 offset:32544
    ds_read_b64_tr_b16 v[34:35], v10 offset:33440
    s_waitcnt lgkmcnt(12)
    v_mfma_f32_32x32x16_bf16 v[88:103], v[36:39], v[12:15], v[88:103]
    ds_read_b64_tr_b16 v[36:37], v10 offset:32576
    ds_read_b64_tr_b16 v[38:39], v10 offset:33472
    s_waitcnt lgkmcnt(12)
    v_mfma_f32_32x32x16_bf16 v[104:119], v[40:43], v[12:15], v[104:119]
    ds_read_b64_tr_b16 v[40:41], v10 offset:32608
    ds_read_b64_tr_b16 v[42:43], v10 offset:33504
    s_waitcnt lgkmcnt(12)
    v_mfma_f32_32x32x16_bf16 v[120:135], v[44:47], v[12:15], v[120:135]
    ds_read_b64_tr_b16 v[44:45], v10 offset:32640
    ds_read_b64_tr_b16 v[46:47], v10 offset:33536
    s_add_u32 m0, s27, 6144
    s_nop 0
    buffer_load_dwordx4 v9, s[8:11], s34 offen lds
    s_waitcnt lgkmcnt(12)
    v_mfma_f32_32x32x16_bf16 v[136:151], v[48:51], v[12:15], v[136:151]
    ds_read_b64_tr_b16 v[48:49], v10 offset:32672
    ds_read_b64_tr_b16 v[50:51], v10 offset:33568
    s_waitcnt lgkmcnt(12)
    v_mfma_f32_32x32x16_bf16 v[152:167], v[52:55], v[12:15], v[152:167]
    ds_read_b64_tr_b16 v[52:53], v10 offset:32704
    ds_read_b64_tr_b16 v[54:55], v10 offset:33600
    s_lshl_b32 s35, s31, 12
    s_add_u32 s35, s35, s33
    s_add_u32 s31, s31, 1
    s_and_b32 s31, s31, 7
    buffer_load_dwordx4 v[12:15], v7, s[20:23], s35 offen offset:0 sc1
    s_waitcnt vmcnt(11)
    s_waitcnt lgkmcnt(12)
    v_mfma_f32_32x32x16_bf16 v[56:71], v[28:31], v[16:19], v[56:71]
    ds_read_b64_tr_b16 v[28:29], v10 offset:36096
    ds_read_b64_tr_b16 v[30:31], v10 offset:36992
    s_waitcnt lgkmcnt(12)
    v_mfma_f32_32x32x16_bf16 v[72:87], v[32:35], v[16:19], v[72:87]
    ds_read_b64_tr_b16 v[32:33], v10 offset:36128
    ds_read_b64_tr_b16 v[34:35], v10 offset:37024
    s_waitcnt lgkmcnt(12)
    v_mfma_f32_32x32x16_bf16 v[88:103], v[36:39], v[16:19], v[88:103]
    ds_read_b64_tr_b16 v[36:37], v10 offset:36160
    ds_read_b64_tr_b16 v[38:39], v10 offset:37056
    s_waitcnt lgkmcnt(12)
    v_mfma_f32_32x32x16_bf16 v[104:119], v[40:43], v[16:19], v[104:119]
    ds_read_b64_tr_b16 v[40:41], v10 offset:36192
    ds_read_b64_tr_b16 v[42:43], v10 offset:37088
    s_waitcnt lgkmcnt(12)
    v_mfma_f32_32x32x16_bf16 v[120:135], v[44:47], v[16:19], v[120:135]
    ds_read_b64_tr_b16 v[44:45], v10 offset:36224
    ds_read_b64_tr_b16 v[46:47], v10 offset:37120
    s_waitcnt lgkmcnt(12)
    v_mfma_f32_32x32x16_bf16 v[136:151], v[48:51], v[16:19], v[136:151]
    ds_read_b64_tr_b16 v[48:49], v10 offset:36256
    ds_read_b64_tr_b16 v[50:51], v10 offset:37152
    s_waitcnt lgkmcnt(12)
    v_mfma_f32_32x32x16_bf16 v[152:167], v[52:55], v[16:19], v[152:167]
    ds_read_b64_tr_b16 v[52:53], v10 offset:36288
    ds_read_b64_tr_b16 v[54:55], v10 offset:37184
    buffer_load_dwordx4 v[16:19], v7, s[20:23], s35 offen offset:1024 sc1
    s_waitcnt vmcnt(10)
    s_waitcnt lgkmcnt(12)
    v_mfma_f32_32x32x16_bf16 v[56:71], v[28:31], v[20:23], v[56:71]
    ds_read_b64_tr_b16 v[28:29], v10 offset:39680
    ds_read_b64_tr_b16 v[30:31], v10 offset:40576
    s_waitcnt lgkmcnt(12)
    v_mfma_f32_32x32x16_bf16 v[72:87], v[32:35], v[20:23], v[72:87]
    ds_read_b64_tr_b16 v[32:33], v10 offset:39712
    ds_read_b64_tr_b16 v[34:35], v10 offset:40608
    s_waitcnt lgkmcnt(12)
    v_mfma_f32_32x32x16_bf16 v[88:103], v[36:39], v[20:23], v[88:103]
    ds_read_b64_tr_b16 v[36:37], v10 offset:39744
    ds_read_b64_tr_b16 v[38:39], v10 offset:40640
    s_waitcnt lgkmcnt(12)
    v_mfma_f32_32x32x16_bf16 v[104:119], v[40:43], v[20:23], v[104:119]
    ds_read_b64_tr_b16 v[40:41], v10 offset:39776
    ds_read_b64_tr_b16 v[42:43], v10 offset:40672
    s_waitcnt lgkmcnt(12)
    v_mfma_f32_32x32x16_bf16 v[120:135], v[44:47], v[20:23], v[120:135]
    ds_read_b64_tr_b16 v[44:45], v10 offset:39808
    ds_read_b64_tr_b16 v[46:47], v10 offset:40704
    s_waitcnt lgkmcnt(12)
    v_mfma_f32_32x32x16_bf16 v[136:151], v[48:51], v[20:23], v[136:151]
    ds_read_b64_tr_b16 v[48:49], v10 offset:39840
    ds_read_b64_tr_b16 v[50:51], v10 offset:40736
    s_waitcnt lgkmcnt(12)
    v_mfma_f32_32x32x16_bf16 v[152:167], v[52:55], v[20:23], v[152:167]
    ds_read_b64_tr_b16 v[52:53], v10 offset:39872
    ds_read_b64_tr_b16 v[54:55], v10 offset:40768
    buffer_load_dwordx4 v[20:23], v7, s[20:23], s35 offen offset:2048 sc1
    s_setprio 2
    s_mov_b64 exec, 2
    ds_add_u32 v7, v7 offset:64
    s_mov_b64 exec, 1
F_bb3:
    ds_read_b32 v1, v7 offset:80
    s_waitcnt lgkmcnt(0)
    v_readfirstlane_b32 s56, v1
    s_cmp_ge_u32 s56, 192
    s_cbranch_scc0 F_bb3
    s_mov_b64 exec, -1
    s_setprio 0
    s_waitcnt vmcnt(5)
    v_mfma_f32_32x32x16_bf16 v[56:71], v[28:31], v[24:27], v[56:71]
    ds_read_b64_tr_b16 v[28:29], v11 offset:0
    ds_read_b64_tr_b16 v[30:31], v11 offset:896
    v_mfma_f32_32x32x16_bf16 v[72:87], v[32:35], v[24:27], v[72:87]
    ds_read_b64_tr_b16 v[32:33], v11 offset:32
    ds_read_b64_tr_b16 v[34:35], v11 offset:928
    v_mfma_f32_32x32x16_bf16 v[88:103], v[36:39], v[24:27], v[88:103]
    ds_read_b64_tr_b16 v[36:37], v11 offset:64
    ds_read_b64_tr_b16 v[38:39], v11 offset:960
    v_mfma_f32_32x32x16_bf16 v[104:119], v[40:43], v[24:27], v[104:119]
    ds_read_b64_tr_b16 v[40:41], v11 offset:96
    ds_read_b64_tr_b16 v[42:43], v11 offset:992
    s_mul_i32 s34, s30, 229376
    s_add_u32 s30, s30, 1
    s_and_b32 s30, s30, 7
    s_add_u32 m0, s27, 28928
    s_nop 0
    buffer_load_dwordx4 v2, s[8:11], s34 offen lds
    v_mfma_f32_32x32x16_bf16 v[120:135], v[44:47], v[24:27], v[120:135]
    ds_read_b64_tr_b16 v[44:45], v11 offset:128
    ds_read_b64_tr_b16 v[46:47], v11 offset:1024
    v_mfma_f32_32x32x16_bf16 v[136:151], v[48:51], v[24:27], v[136:151]
    ds_read_b64_tr_b16 v[48:49], v11 offset:160
    ds_read_b64_tr_b16 v[50:51], v11 offset:1056
    v_mfma_f32_32x32x16_bf16 v[152:167], v[52:55], v[24:27], v[152:167]
    ds_read_b64_tr_b16 v[52:53], v11 offset:192
    ds_read_b64_tr_b16 v[54:55], v11 offset:1088
    buffer_load_dwordx4 v[24:27], v7, s[20:23], s35 offen offset:3072 sc1
    s_waitcnt vmcnt(4)
    s_waitcnt lgkmcnt(12)
    v_mfma_f32_32x32x16_bf16 v[56:71], v[28:31], v[12:15], v[56:71]
    ds_read_b64_tr_b16 v[28:29], v11 offset:3584
    ds_read_b64_tr_b16 v[30:31], v11 offset:4480
    s_add_u32 m0, s27, 29952
    s_nop 0
    buffer_load_dwordx4 v3, s[8:11], s34 offen lds
    s_waitcnt lgkmcnt(12)
    v_mfma_f32_32x32x16_bf16 v[72:87], v[32:35], v[12:15], v[72:87]
    ds_read_b64_tr_b16 v[32:33], v11 offset:3616
    ds_read_b64_tr_b16 v[34:35], v11 offset:4512
    s_waitcnt lgkmcnt(12)
    v_mfma_f32_32x32x16_bf16 v[88:103], v[36:39], v[12:15], v[88:103]
    ds_read_b64_tr_b16 v[36:37], v11 offset:3648
    ds_read_b64_tr_b16 v[38:39], v11 offset:4544
    s_waitcnt lgkmcnt(12)
    v_mfma_f32_32x32x16_bf16 v[104:119], v[40:43], v[12:15], v[104:119]
    ds_read_b64_tr_b16 v[40:41], v11 offset:3680
    ds_read_b64_tr_b16 v[42:43], v11 offset:4576
    s_waitcnt lgkmcnt(12)
    v_mfma_f32_32x32x16_bf16 v[120:135], v[44:47], v[12:15], v[120:135]
    ds_read_b64_tr_b16 v[44:45], v11 offset:3712
    ds_read_b64_tr_b16 v[46:47], v11 offset:4608
    s_add_u32 m0, s27, 30976
    s_nop 0
    buffer_load_dwordx4 v4, s[8:11], s34 offen lds
    s_waitcnt lgkmcnt(12)
    v_mfma_f32_32x32x16_bf16 v[136:151], v[48:51], v[12:15], v[136:151]
    ds_read_b64_tr_b16 v[48:49], v11 offset:3744
    ds_read_b64_tr_b16 v[50:51], v11 offset:4640
    s_waitcnt lgkmcnt(12)
    v_mfma_f32_32x32x16_bf16 v[152:167], v[52:55], v[12:15], v[152:167]
    ds_read_b64_tr_b16 v[52:53], v11 offset:3776
    ds_read_b64_tr_b16 v[54:55], v11 offset:4672
    s_lshl_b32 s35, s31, 12
    s_add_u32 s35, s35, s33
    s_add_u32 s31, s31, 1
    s_and_b32 s31, s31, 7
    buffer_load_dwordx4 v[12:15], v7, s[20:23], s35 offen offset:0 sc1
    s_waitcnt vmcnt(6)
    s_waitcnt lgkmcnt(12)
    v_mfma_f32_32x32x16_bf16 v[56:71], v[28:31], v[16:19], v[56:71]
    ds_read_b64_tr_b16 v[28:29], v11 offset:7168
    ds_read_b64_tr_b16 v[30:31], v11 offset:8064
    s_waitcnt lgkmcnt(12)
    v_mfma_f32_32x32x16_bf16 v[72:87], v[32:35], v[16:19], v[72:87]
    ds_read_b64_tr_b16 v[32:33], v11 offset:7200
    ds_read_b64_tr_b16 v[34:35], v11 offset:8096
    s_add_u32 m0, s27, 32000
    s_nop 0
    buffer_load_dwordx4 v5, s[8:11], s34 offen lds
    s_waitcnt lgkmcnt(12)
    v_mfma_f32_32x32x16_bf16 v[88:103], v[36:39], v[16:19], v[88:103]
    ds_read_b64_tr_b16 v[36:37], v11 offset:7232
    ds_read_b64_tr_b16 v[38:39], v11 offset:8128
    s_waitcnt lgkmcnt(12)
    v_mfma_f32_32x32x16_bf16 v[104:119], v[40:43], v[16:19], v[104:119]
    ds_read_b64_tr_b16 v[40:41], v11 offset:7264
    ds_read_b64_tr_b16 v[42:43], v11 offset:8160
    s_waitcnt lgkmcnt(12)
    v_mfma_f32_32x32x16_bf16 v[120:135], v[44:47], v[16:19], v[120:135]
    ds_read_b64_tr_b16 v[44:45], v11 offset:7296
    ds_read_b64_tr_b16 v[46:47], v11 offset:8192
    s_waitcnt lgkmcnt(12)
    v_mfma_f32_32x32x16_bf16 v[136:151], v[48:51], v[16:19], v[136:151]
    ds_read_b64_tr_b16 v[48:49], v11 offset:7328
    ds_read_b64_tr_b16 v[50:51], v11 offset:8224
    s_add_u32 m0, s27, 33024
    s_nop 0
    buffer_load_dwordx4 v6, s[8:11], s34 offen lds
    s_waitcnt lgkmcnt(12)
    v_mfma_f32_32x32x16_bf16 v[152:167], v[52:55], v[16:19], v[152:167]
    ds_read_b64_tr_b16 v[52:53], v11 offset:7360
    ds_read_b64_tr_b16 v[54:55], v11 offset:8256
    buffer_load_dwordx4 v[16:19], v7, s[20:23], s35 offen offset:1024 sc1
    s_waitcnt vmcnt(8)
    s_waitcnt lgkmcnt(12)
    v_mfma_f32_32x32x16_bf16 v[56:71], v[28:31], v[20:23], v[56:71]
    ds_read_b64_tr_b16 v[28:29], v11 offset:10752
    ds_read_b64_tr_b16 v[30:31], v11 offset:11648
    s_waitcnt lgkmcnt(12)
    v_mfma_f32_32x32x16_bf16 v[72:87], v[32:35], v[20:23], v[72:87]
    ds_read_b64_tr_b16 v[32:33], v11 offset:10784
    ds_read_b64_tr_b16 v[34:35], v11 offset:11680
    s_waitcnt lgkmcnt(12)
    v_mfma_f32_32x32x16_bf16 v[88:103], v[36:39], v[20:23], v[88:103]
    ds_read_b64_tr_b16 v[36:37], v11 offset:10816
    ds_read_b64_tr_b16 v[38:39], v11 offset:11712
    s_add_u32 m0, s27, 34048
    s_nop 0
    buffer_load_dwordx4 v8, s[8:11], s34 offen lds
    s_waitcnt lgkmcnt(12)
    v_mfma_f32_32x32x16_bf16 v[104:119], v[40:43], v[20:23], v[104:119]
    ds_read_b64_tr_b16 v[40:41], v11 offset:10848
    ds_read_b64_tr_b16 v[42:43], v11 offset:11744
    s_waitcnt lgkmcnt(12)
    v_mfma_f32_32x32x16_bf16 v[120:135], v[44:47], v[20:23], v[120:135]
    ds_read_b64_tr_b16 v[44:45], v11 offset:10880
    ds_read_b64_tr_b16 v[46:47], v11 offset:11776
    s_waitcnt lgkmcnt(12)
    v_mfma_f32_32x32x16_bf16 v[136:151], v[48:51], v[20:23], v[136:151]
    ds_read_b64_tr_b16 v[48:49], v11 offset:10912
    ds_read_b64_tr_b16 v[50:51], v11 offset:11808
    s_waitcnt lgkmcnt(12)
    v_mfma_f32_32x32x16_bf16 v[152:167], v[52:55], v[20:23], v[152:167]
    ds_read_b64_tr_b16 v[52:53], v11 offset:10944
    ds_read_b64_tr_b16 v[54:55], v11 offset:11840
    s_add_u32 m0, s27, 35072
    s_nop 0
    buffer_load_dwordx4 v9, s[8:11], s34 offen lds
    buffer_load_dwordx4 v[20:23], v7, s[20:23], s35 offen offset:2048 sc1
    s_setprio 2
    s_mov_b64 exec, 2
    ds_add_u32 v7, v7 offset:64
    s_mov_b64 exec, 1
F_bb4:
    ds_read_b32 v1, v7 offset:80
    s_waitcnt lgkmcnt(0)
    v_readfirstlane_b32 s56, v1
    s_cmp_ge_u32 s56, 256
    s_cbranch_scc0 F_bb4
    s_mov_b64 exec, -1
    s_setprio 0
    s_waitcnt vmcnt(9)
    v_mfma_f32_32x32x16_bf16 v[56:71], v[28:31], v[24:27], v[56:71]
    ds_read_b64_tr_b16 v[28:29], v10 offset:0
    ds_read_b64_tr_b16 v[30:31], v10 offset:896
    v_mfma_f32_32x32x16_bf16 v[72:87], v[32:35], v[24:27], v[72:87]
    ds_read_b64_tr_b16 v[32:33], v10 offset:32
    ds_read_b64_tr_b16 v[34:35], v10 offset:928
    v_mfma_f32_32x32x16_bf16 v[88:103], v[36:39], v[24:27], v[88:103]
    ds_read_b64_tr_b16 v[36:37], v10 offset:64
    ds_read_b64_tr_b16 v[38:39], v10 offset:960
    v_mfma_f32_32x32x16_bf16 v[104:119], v[40:43], v[24:27], v[104:119]
    ds_read_b64_tr_b16 v[40:41], v10 offset:96
    ds_read_b64_tr_b16 v[42:43], v10 offset:992
    s_mul_i32 s34, s30, 229376
    s_add_u32 s30, s30, 1
    s_and_b32 s30, s30, 7
    s_add_u32 m0, s27, 57856
    s_nop 0
    buffer_load_dwordx4 v2, s[8:11], s34 offen lds
    v_mfma_f32_32x32x16_bf16 v[120:135], v[44:47], v[24:27], v[120:135]
    ds_read_b64_tr_b16 v[44:45], v10 offset:128
    ds_read_b64_tr_b16 v[46:47], v10 offset:1024
    v_mfma_f32_32x32x16_bf16 v[136:151], v[48:51], v[24:27], v[136:151]
    ds_read_b64_tr_b16 v[48:49], v10 offset:160
    ds_read_b64_tr_b16 v[50:51], v10 offset:1056
    v_mfma_f32_32x32x16_bf16 v[152:167], v[52:55], v[24:27], v[152:167]
    ds_read_b64_tr_b16 v[52:53], v10 offset:192
    ds_read_b64_tr_b16 v[54:55], v10 offset:1088
    buffer_load_dwordx4 v[24:27], v7, s[20:23], s35 offen offset:3072 sc1
    s_waitcnt vmcnt(8)
    s_waitcnt lgkmcnt(12)
    v_mfma_f32_32x32x16_bf16 v[56:71], v[28:31], v[12:15], v[56:71]
    ds_read_b64_tr_b16 v[28:29], v10 offset:3584
    ds_read_b64_tr_b16 v[30:31], v10 offset:4480
    s_add_u32 m0, s27, 58880
    s_nop 0
    buffer_load_dwordx4 v3, s[8:11], s34 offen lds
    s_waitcnt lgkmcnt(12)
    v_mfma_f32_32x32x16_bf16 v[72:87], v[32:35], v[12:15], v[72:87]
    ds_read_b64_tr_b16 v[32:33], v10 offset:3616
    ds_read_b64_tr_b16 v[34:35], v10 offset:4512
    s_waitcnt lgkmcnt(12)
    v_mfma_f32_32x32x16_bf16 v[88:103], v[36:39], v[12:15], v[88:103]
    ds_read_b64_tr_b16 v[36:37], v10 offset:3648
    ds_read_b64_tr_b16 v[38:39], v10 offset:4544
    s_waitcnt lgkmcnt(12)
    v_mfma_f32_32x32x16_bf16 v[104:119], v[40:43], v[12:15], v[104:119]
    ds_read_b64_tr_b16 v[40:41], v10 offset:3680
    ds_read_b64_tr_b16 v[42:43], v10 offset:4576
    s_waitcnt lgkmcnt(12)
    v_mfma_f32_32x32x16_bf16 v[120:135], v[44:47], v[12:15], v[120:135]
    ds_read_b64_tr_b16 v[44:45], v10 offset:3712
    ds_read_b64_tr_b16 v[46:47], v10 offset:4608
    s_add_u32 m0, s27, 59904
    s_nop 0
    buffer_load_dwordx4 v4, s[8:11], s34 offen lds
    s_waitcnt lgkmcnt(12)
    v_mfma_f32_32x32x16_bf16 v[136:151], v[48:51], v[12:15], v[136:151]
    ds_read_b64_tr_b16 v[48:49], v10 offset:3744
    ds_read_b64_tr_b16 v[50:51], v10 offset:4640
    s_waitcnt lgkmcnt(12)
    v_mfma_f32_32x32x16_bf16 v[152:167], v[52:55], v[12:15], v[152:167]
    ds_read_b64_tr_b16 v[52:53], v10 offset:3776
    ds_read_b64_tr_b16 v[54:55], v10 offset:4672
    s_lshl_b32 s35, s31, 12
    s_add_u32 s35, s35, s33
    s_add_u32 s31, s31, 1
    s_and_b32 s31, s31, 7
    buffer_load_dwordx4 v[12:15], v7, s[20:23], s35 offen offset:0 sc1
    s_waitcnt vmcnt(8)
    s_waitcnt lgkmcnt(12)
    v_mfma_f32_32x32x16_bf16 v[56:71], v[28:31], v[16:19], v[56:71]
    ds_read_b64_tr_b16 v[28:29], v10 offset:7168
    ds_read_b64_tr_b16 v[30:31], v10 offset:8064
    s_waitcnt lgkmcnt(12)
    v_mfma_f32_32x32x16_bf16 v[72:87], v[32:35], v[16:19], v[72:87]
    ds_read_b64_tr_b16 v[32:33], v10 offset:7200
    ds_read_b64_tr_b16 v[34:35], v10 offset:8096
    s_add_u32 m0, s27, 60928
    s_nop 0
    buffer_load_dwordx4 v5, s[8:11], s34 offen lds
    s_waitcnt lgkmcnt(12)
    v_mfma_f32_32x32x16_bf16 v[88:103], v[36:39], v[16:19], v[88:103]
    ds_read_b64_tr_b16 v[36:37], v10 offset:7232
    ds_read_b64_tr_b16 v[38:39], v10 offset:8128
    s_waitcnt lgkmcnt(12)
    v_mfma_f32_32x32x16_bf16 v[104:119], v[40:43], v[16:19], v[104:119]
    ds_read_b64_tr_b16 v[40:41], v10 offset:7264
    ds_read_b64_tr_b16 v[42:43], v10 offset:8160
    s_waitcnt lgkmcnt(12)
    v_mfma_f32_32x32x16_bf16 v[120:135], v[44:47], v[16:19], v[120:135]
    ds_read_b64_tr_b16 v[44:45], v10 offset:7296
    ds_read_b64_tr_b16 v[46:47], v10 offset:8192
    s_waitcnt lgkmcnt(12)
    v_mfma_f32_32x32x16_bf16 v[136:151], v[48:51], v[16:19], v[136:151]
    ds_read_b64_tr_b16 v[48:49], v10 offset:7328
    ds_read_b64_tr_b16 v[50:51], v10 offset:8224
    s_add_u32 m0, s27, 61952
    s_nop 0
    buffer_load_dwordx4 v6, s[8:11], s34 offen lds
    s_waitcnt lgkmcnt(12)
    v_mfma_f32_32x32x16_bf16 v[152:167], v[52:55], v[16:19], v[152:167]
    ds_read_b64_tr_b16 v[52:53], v10 offset:7360
    ds_read_b64_tr_b16 v[54:55], v10 offset:8256
    buffer_load_dwordx4 v[16:19], v7, s[20:23], s35 offen offset:1024 sc1
    s_waitcnt vmcnt(8)
    s_waitcnt lgkmcnt(12)
    v_mfma_f32_32x32x16_bf16 v[56:71], v[28:31], v[20:23], v[56:71]
    ds_read_b64_tr_b16 v[28:29], v10 offset:10752
    ds_read_b64_tr_b16 v[30:31], v10 offset:11648
    s_waitcnt lgkmcnt(12)
    v_mfma_f32_32x32x16_bf16 v[72:87], v[32:35], v[20:23], v[72:87]
    ds_read_b64_tr_b16 v[32:33], v10 offset:10784
    ds_read_b64_tr_b16 v[34:35], v10 offset:11680
    s_waitcnt lgkmcnt(12)
    v_mfma_f32_32x32x16_bf16 v[88:103], v[36:39], v[20:23], v[88:103]
    ds_read_b64_tr_b16 v[36:37], v10 offset:10816
    ds_read_b64_tr_b16 v[38:39], v10 offset:11712
    s_add_u32 m0, s27, 62976
    s_nop 0
    buffer_load_dwordx4 v8, s[8:11], s34 offen lds
    s_waitcnt lgkmcnt(12)
    v_mfma_f32_32x32x16_bf16 v[104:119], v[40:43], v[20:23], v[104:119]
    ds_read_b64_tr_b16 v[40:41], v10 offset:10848
    ds_read_b64_tr_b16 v[42:43], v10 offset:11744
    s_waitcnt lgkmcnt(12)
    v_mfma_f32_32x32x16_bf16 v[120:135], v[44:47], v[20:23], v[120:135]
    ds_read_b64_tr_b16 v[44:45], v10 offset:10880
    ds_read_b64_tr_b16 v[46:47], v10 offset:11776
    s_waitcnt lgkmcnt(12)
    v_mfma_f32_32x32x16_bf16 v[136:151], v[48:51], v[20:23], v[136:151]
    ds_read_b64_tr_b16 v[48:49], v10 offset:10912
    ds_read_b64_tr_b16 v[50:51], v10 offset:11808
    s_waitcnt lgkmcnt(12)
    v_mfma_f32_32x32x16_bf16 v[152:167], v[52:55], v[20:23], v[152:167]
    ds_read_b64_tr_b16 v[52:53], v10 offset:10944
    ds_read_b64_tr_b16 v[54:55], v10 offset:11840
    s_add_u32 m0, s27, 64000
    s_nop 0
    buffer_load_dwordx4 v9, s[8:11], s34 offen lds
    buffer_load_dwordx4 v[20:23], v7, s[20:23], s35 offen offset:2048 sc1
    s_setprio 2
    s_mov_b64 exec, 2
    ds_add_u32 v7, v7 offset:64
    s_mov_b64 exec, 1
F_bb5:
    ds_read_b32 v1, v7 offset:80
    s_waitcnt lgkmcnt(0)
    v_readfirstlane_b32 s56, v1
    s_cmp_ge_u32 s56, 320
    s_cbranch_scc0 F_bb5
    s_mov_b64 exec, -1
    s_setprio 0
    s_waitcnt vmcnt(9)
    v_mfma_f32_32x32x16_bf16 v[56:71], v[28:31], v[24:27], v[56:71]
    ds_read_b64_tr_b16 v[28:29], v10 offset:28928
    ds_read_b64_tr_b16 v[30:31], v10 offset:29824
    v_mfma_f32_32x32x16_bf16 v[72:87], v[32:35], v[24:27], v[72:87]
    ds_read_b64_tr_b16 v[32:33], v10 offset:28960
    ds_read_b64_tr_b16 v[34:35], v10 offset:29856
    v_mfma_f32_32x32x16_bf16 v[88:103], v[36:39], v[24:27], v[88:103]
    ds_read_b64_tr_b16 v[36:37], v10 offset:28992
    ds_read_b64_tr_b16 v[38:39], v10 offset:29888
    v_mfma_f32_32x32x16_bf16 v[104:119], v[40:43], v[24:27], v[104:119]
    ds_read_b64_tr_b16 v[40:41], v10 offset:29024
    ds_read_b64_tr_b16 v[42:43], v10 offset:29920
    s_mul_i32 s34, s30, 229376
    s_add_u32 s30, s30, 1
    s_and_b32 s30, s30, 7
    s_add_u32 m0, s27, 0
    s_nop 0
    buffer_load_dwordx4 v2, s[8:11], s34 offen lds
    v_mfma_f32_32x32x16_bf16 v[120:135], v[44:47], v[24:27], v[120:135]
    ds_read_b64_tr_b16 v[44:45], v10 offset:29056
    ds_read_b64_tr_b16 v[46:47], v10 offset:29952
    v_mfma_f32_32x32x16_bf16 v[136:151], v[48:51], v[24:27], v[136:151]
    ds_read_b64_tr_b16 v[48:49], v10 offset:29088
    ds_read_b64_tr_b16 v[50:51], v10 offset:29984
    v_mfma_f32_32x32x16_bf16 v[152:167], v[52:55], v[24:27], v[152:167]
    ds_read_b64_tr_b16 v[52:53], v10 offset:29120
    ds_read_b64_tr_b16 v[54:55], v10 offset:30016
    buffer_load_dwordx4 v[24:27], v7, s[20:23], s35 offen offset:3072 sc1
    s_waitcnt vmcnt(8)
    s_waitcnt lgkmcnt(12)
    v_mfma_f32_32x32x16_bf16 v[56:71], v[28:31], v[12:15], v[56:71]
    ds_read_b64_tr_b16 v[28:29], v10 offset:32512
    ds_read_b64_tr_b16 v[30:31], v10 offset:33408
    s_add_u32 m0, s27, 1024
    s_nop 0
    buffer_load_dwordx4 v3, s[8:11], s34 offen lds
    s_waitcnt lgkmcnt(12)
    v_mfma_f32_32x32x16_bf16 v[72:87], v[32:35], v[12:15], v[72:87]
    ds_read_b64_tr_b16 v[32:33], v10 offset:32544
    ds_read_b64_tr_b16 v[34:35], v10 offset:33440
    s_waitcnt lgkmcnt(12)
    v_mfma_f32_32x32x16_bf16 v[88:103], v[36:39], v[12:15], v[88:103]
    ds_read_b64_tr_b16 v[36:37], v10 offset:32576
    ds_read_b64_tr_b16 v[38:39], v10 offset:33472
    s_waitcnt lgkmcnt(12)
    v_mfma_f32_32x32x16_bf16 v[104:119], v[40:43], v[12:15], v[104:119]
    ds_read_b64_tr_b16 v[40:41], v10 offset:32608
    ds_read_b64_tr_b16 v[42:43], v10 offset:33504
    s_waitcnt lgkmcnt(12)
    v_mfma_f32_32x32x16_bf16 v[120:135], v[44:47], v[12:15], v[120:135]
    ds_read_b64_tr_b16 v[44:45], v10 offset:32640
    ds_read_b64_tr_b16 v[46:47], v10 offset:33536
    s_add_u32 m0, s27, 2048
    s_nop 0
    buffer_load_dwordx4 v4, s[8:11], s34 offen lds
    s_waitcnt lgkmcnt(12)
    v_mfma_f32_32x32x16_bf16 v[136:151], v[48:51], v[12:15], v[136:151]
    ds_read_b64_tr_b16 v[48:49], v10 offset:32672
    ds_read_b64_tr_b16 v[50:51], v10 offset:33568
    s_waitcnt lgkmcnt(12)
    v_mfma_f32_32x32x16_bf16 v[152:167], v[52:55], v[12:15], v[152:167]
    ds_read_b64_tr_b16 v[52:53], v10 offset:32704
    ds_read_b64_tr_b16 v[54:55], v10 offset:33600
    s_lshl_b32 s35, s31, 12
    s_add_u32 s35, s35, s33
    s_add_u32 s31, s31, 1
    s_and_b32 s31, s31, 7
    buffer_load_dwordx4 v[12:15], v7, s[20:23], s35 offen offset:0 sc1
    s_waitcnt vmcnt(8)
    s_waitcnt lgkmcnt(12)
    v_mfma_f32_32x32x16_bf16 v[56:71], v[28:31], v[16:19], v[56:71]
    ds_read_b64_tr_b16 v[28:29], v10 offset:36096
    ds_read_b64_tr_b16 v[30:31], v10 offset:36992
    s_waitcnt lgkmcnt(12)
    v_mfma_f32_32x32x16_bf16 v[72:87], v[32:35], v[16:19], v[72:87]
    ds_read_b64_tr_b16 v[32:33], v10 offset:36128
    ds_read_b64_tr_b16 v[34:35], v10 offset:37024
    s_add_u32 m0, s27, 3072
    s_nop 0
    buffer_load_dwordx4 v5, s[8:11], s34 offen lds
    s_waitcnt lgkmcnt(12)
    v_mfma_f32_32x32x16_bf16 v[88:103], v[36:39], v[16:19], v[88:103]
    ds_read_b64_tr_b16 v[36:37], v10 offset:36160
    ds_read_b64_tr_b16 v[38:39], v10 offset:37056
    s_waitcnt lgkmcnt(12)
    v_mfma_f32_32x32x16_bf16 v[104:119], v[40:43], v[16:19], v[104:119]
    ds_read_b64_tr_b16 v[40:41], v10 offset:36192
    ds_read_b64_tr_b16 v[42:43], v10 offset:37088
    s_waitcnt lgkmcnt(12)
    v_mfma_f32_32x32x16_bf16 v[120:135], v[44:47], v[16:19], v[120:135]
    ds_read_b64_tr_b16 v[44:45], v10 offset:36224
    ds_read_b64_tr_b16 v[46:47], v10 offset:37120
    s_waitcnt lgkmcnt(12)
    v_mfma_f32_32x32x16_bf16 v[136:151], v[48:51], v[16:19], v[136:151]
    ds_read_b64_tr_b16 v[48:49], v10 offset:36256
    ds_read_b64_tr_b16 v[50:51], v10 offset:37152
    s_add_u32 m0, s27, 4096
    s_nop 0
    buffer_load_dwordx4 v6, s[8:11], s34 offen lds
    s_waitcnt lgkmcnt(12)
    v_mfma_f32_32x32x16_bf16 v[152:167], v[52:55], v[16:19], v[152:167]
    ds_read_b64_tr_b16 v[52:53], v10 offset:36288
    ds_read_b64_tr_b16 v[54:55], v10 offset:37184
    buffer_load_dwordx4 v[16:19], v7, s[20:23], s35 offen offset:1024 sc1
    s_waitcnt vmcnt(8)
    s_waitcnt lgkmcnt(12)
    v_mfma_f32_32x32x16_bf16 v[56:71], v[28:31], v[20:23], v[56:71]
    ds_read_b64_tr_b16 v[28:29], v10 offset:39680
    ds_read_b64_tr_b16 v[30:31], v10 offset:40576
    s_waitcnt lgkmcnt(12)
    v_mfma_f32_32x32x16_bf16 v[72:87], v[32:35], v[20:23], v[72:87]
    ds_read_b64_tr_b16 v[32:33], v10 offset:39712
    ds_read_b64_tr_b16 v[34:35], v10 offset:40608
    s_waitcnt lgkmcnt(12)
    v_mfma_f32_32x32x16_bf16 v[88:103], v[36:39], v[20:23], v[88:103]
    ds_read_b64_tr_b16 v[36:37], v10 offset:39744
    ds_read_b64_tr_b16 v[38:39], v10 offset:40640
    s_add_u32 m0, s27, 5120
    s_nop 0
    buffer_load_dwordx4 v8, s[8:11], s34 offen lds
    s_waitcnt lgkmcnt(12)
    v_mfma_f32_32x32x16_bf16 v[104:119], v[40:43], v[20:23], v[104:119]
    ds_read_b64_tr_b16 v[40:41], v10 offset:39776
    ds_read_b64_tr_b16 v[42:43], v10 offset:40672
    s_waitcnt lgkmcnt(12)
    v_mfma_f32_32x32x16_bf16 v[120:135], v[44:47], v[20:23], v[120:135]
    ds_read_b64_tr_b16 v[44:45], v10 offset:39808
    ds_read_b64_tr_b16 v[46:47], v10 offset:40704
    s_waitcnt lgkmcnt(12)
    v_mfma_f32_32x32x16_bf16 v[136:151], v[48:51], v[20:23], v[136:151]
    ds_read_b64_tr_b16 v[48:49], v10 offset:39840
    ds_read_b64_tr_b16 v[50:51], v10 offset:40736
    s_waitcnt lgkmcnt(12)
    v_mfma_f32_32x32x16_bf16 v[152:167], v[52:55], v[20:23], v[152:167]
    ds_read_b64_tr_b16 v[52:53], v10 offset:39872
    ds_read_b64_tr_b16 v[54:55], v10 offset:40768
    s_add_u32 m0, s27, 6144
    s_nop 0
    buffer_load_dwordx4 v9, s[8:11], s34 offen lds
    buffer_load_dwordx4 v[20:23], v7, s[20:23], s35 offen offset:2048 sc1
    s_setprio 2
    s_mov_b64 exec, 2
    ds_add_u32 v7, v7 offset:64
    s_mov_b64 exec, 1
F_bb6:
    ds_read_b32 v1, v7 offset:80
    s_waitcnt lgkmcnt(0)
    v_readfirstlane_b32 s56, v1
    s_cmp_ge_u32 s56, 384
    s_cbranch_scc0 F_bb6
    s_mov_b64 exec, -1
    s_setprio 0
    s_waitcnt vmcnt(9)
    v_mfma_f32_32x32x16_bf16 v[56:71], v[28:31], v[24:27], v[56:71]
    ds_read_b64_tr_b16 v[28:29], v11 offset:0
    ds_read_b64_tr_b16 v[30:31], v11 offset:896
    v_mfma_f32_32x32x16_bf16 v[72:87], v[32:35], v[24:27], v[72:87]
    ds_read_b64_tr_b16 v[32:33], v11 offset:32
    ds_read_b64_tr_b16 v[34:35], v11 offset:928
    v_mfma_f32_32x32x16_bf16 v[88:103], v[36:39], v[24:27], v[88:103]
    ds_read_b64_tr_b16 v[36:37], v11 offset:64
    ds_read_b64_tr_b16 v[38:39], v11 offset:960
    v_mfma_f32_32x32x16_bf16 v[104:119], v[40:43], v[24:27], v[104:119]
    ds_read_b64_tr_b16 v[40:41], v11 offset:96
    ds_read_b64_tr_b16 v[42:43], v11 offset:992
    s_mul_i32 s34, s30, 229376
    s_add_u32 s30, s30, 1
    s_and_b32 s30, s30, 7
    s_add_u32 m0, s27, 28928
    s_nop 0
    buffer_load_dwordx4 v2, s[8:11], s34 offen lds
    v_mfma_f32_32x32x16_bf16 v[120:135], v[44:47], v[24:27], v[120:135]
    ds_read_b64_tr_b16 v[44:45], v11 offset:128
    ds_read_b64_tr_b16 v[46:47], v11 offset:1024
    v_mfma_f32_32x32x16_bf16 v[136:151], v[48:51], v[24:27], v[136:151]
    ds_read_b64_tr_b16 v[48:49], v11 offset:160
    ds_read_b64_tr_b16 v[50:51], v11 offset:1056
    v_mfma_f32_32x32x16_bf16 v[152:167], v[52:55], v[24:27], v[152:167]
    ds_read_b64_tr_b16 v[52:53], v11 offset:192
    ds_read_b64_tr_b16 v[54:55], v11 offset:1088
    buffer_load_dwordx4 v[24:27], v7, s[20:23], s35 offen offset:3072 sc1
    s_waitcnt vmcnt(8)
    s_waitcnt lgkmcnt(12)
    v_mfma_f32_32x32x16_bf16 v[56:71], v[28:31], v[12:15], v[56:71]
    ds_read_b64_tr_b16 v[28:29], v11 offset:3584
    ds_read_b64_tr_b16 v[30:31], v11 offset:4480
    s_add_u32 m0, s27, 29952
    s_nop 0
    buffer_load_dwordx4 v3, s[8:11], s34 offen lds
    s_waitcnt lgkmcnt(12)
    v_mfma_f32_32x32x16_bf16 v[72:87], v[32:35], v[12:15], v[72:87]
    ds_read_b64_tr_b16 v[32:33], v11 offset:3616
    ds_read_b64_tr_b16 v[34:35], v11 offset:4512
    s_waitcnt lgkmcnt(12)
    v_mfma_f32_32x32x16_bf16 v[88:103], v[36:39], v[12:15], v[88:103]
    ds_read_b64_tr_b16 v[36:37], v11 offset:3648
    ds_read_b64_tr_b16 v[38:39], v11 offset:4544
    s_waitcnt lgkmcnt(12)
    v_mfma_f32_32x32x16_bf16 v[104:119], v[40:43], v[12:15], v[104:119]
    ds_read_b64_tr_b16 v[40:41], v11 offset:3680
    ds_read_b64_tr_b16 v[42:43], v11 offset:4576
    s_waitcnt lgkmcnt(12)
    v_mfma_f32_32x32x16_bf16 v[120:135], v[44:47], v[12:15], v[120:135]
    ds_read_b64_tr_b16 v[44:45], v11 offset:3712
    ds_read_b64_tr_b16 v[46:47], v11 offset:4608
    s_add_u32 m0, s27, 30976
    s_nop 0
    buffer_load_dwordx4 v4, s[8:11], s34 offen lds
    s_waitcnt lgkmcnt(12)
    v_mfma_f32_32x32x16_bf16 v[136:151], v[48:51], v[12:15], v[136:151]
    ds_read_b64_tr_b16 v[48:49], v11 offset:3744
    ds_read_b64_tr_b16 v[50:51], v11 offset:4640
    s_waitcnt lgkmcnt(12)
    v_mfma_f32_32x32x16_bf16 v[152:167], v[52:55], v[12:15], v[152:167]
    ds_read_b64_tr_b16 v[52:53], v11 offset:3776
    ds_read_b64_tr_b16 v[54:55], v11 offset:4672
    s_lshl_b32 s35, s31, 12
    s_add_u32 s35, s35, s33
    s_add_u32 s31, s31, 1
    s_and_b32 s31, s31, 7
    buffer_load_dwordx4 v[12:15], v7, s[20:23], s35 offen offset:0 sc1
    s_waitcnt vmcnt(8)
    s_waitcnt lgkmcnt(12)
    v_mfma_f32_32x32x16_bf16 v[56:71], v[28:31], v[16:19], v[56:71]
    ds_read_b64_tr_b16 v[28:29], v11 offset:7168
    ds_read_b64_tr_b16 v[30:31], v11 offset:8064
    s_waitcnt lgkmcnt(12)
    v_mfma_f32_32x32x16_bf16 v[72:87], v[32:35], v[16:19], v[72:87]
    ds_read_b64_tr_b16 v[32:33], v11 offset:7200
    ds_read_b64_tr_b16 v[34:35], v11 offset:8096
    s_add_u32 m0, s27, 32000
    s_nop 0
    buffer_load_dwordx4 v5, s[8:11], s34 offen lds
    s_waitcnt lgkmcnt(12)
    v_mfma_f32_32x32x16_bf16 v[88:103], v[36:39], v[16:19], v[88:103]
    ds_read_b64_tr_b16 v[36:37], v11 offset:7232
    ds_read_b64_tr_b16 v[38:39], v11 offset:8128
    s_waitcnt lgkmcnt(12)
    v_mfma_f32_32x32x16_bf16 v[104:119], v[40:43], v[16:19], v[104:119]
    ds_read_b64_tr_b16 v[40:41], v11 offset:7264
    ds_read_b64_tr_b16 v[42:43], v11 offset:8160
    s_waitcnt lgkmcnt(12)
    v_mfma_f32_32x32x16_bf16 v[120:135], v[44:47], v[16:19], v[120:135]
    ds_read_b64_tr_b16 v[44:45], v11 offset:7296
    ds_read_b64_tr_b16 v[46:47], v11 offset:8192
    s_waitcnt lgkmcnt(12)
    v_mfma_f32_32x32x16_bf16 v[136:151], v[48:51], v[16:19], v[136:151]
    ds_read_b64_tr_b16 v[48:49], v11 offset:7328
    ds_read_b64_tr_b16 v[50:51], v11 offset:8224
    s_add_u32 m0, s27, 33024
    s_nop 0
    buffer_load_dwordx4 v6, s[8:11], s34 offen lds
    s_waitcnt lgkmcnt(12)
    v_mfma_f32_32x32x16_bf16 v[152:167], v[52:55], v[16:19], v[152:167]
    ds_read_b64_tr_b16 v[52:53], v11 offset:7360
    ds_read_b64_tr_b16 v[54:55], v11 offset:8256
    buffer_load_dwordx4 v[16:19], v7, s[20:23], s35 offen offset:1024 sc1
    s_waitcnt vmcnt(8)
    s_waitcnt lgkmcnt(12)
    v_mfma_f32_32x32x16_bf16 v[56:71], v[28:31], v[20:23], v[56:71]
    ds_read_b64_tr_b16 v[28:29], v11 offset:10752
    ds_read_b64_tr_b16 v[30:31], v11 offset:11648
    s_waitcnt lgkmcnt(12)
    v_mfma_f32_32x32x16_bf16 v[72:87], v[32:35], v[20:23], v[72:87]
    ds_read_b64_tr_b16 v[32:33], v11 offset:10784
    ds_read_b64_tr_b16 v[34:35], v11 offset:11680
    s_waitcnt lgkmcnt(12)
    v_mfma_f32_32x32x16_bf16 v[88:103], v[36:39], v[20:23], v[88:103]
    ds_read_b64_tr_b16 v[36:37], v11 offset:10816
    ds_read_b64_tr_b16 v[38:39], v11 offset:11712
    s_add_u32 m0, s27, 34048
    s_nop 0
    buffer_load_dwordx4 v8, s[8:11], s34 offen lds
    s_waitcnt lgkmcnt(12)
    v_mfma_f32_32x32x16_bf16 v[104:119], v[40:43], v[20:23], v[104:119]
    ds_read_b64_tr_b16 v[40:41], v11 offset:10848
    ds_read_b64_tr_b16 v[42:43], v11 offset:11744
    s_waitcnt lgkmcnt(12)
    v_mfma_f32_32x32x16_bf16 v[120:135], v[44:47], v[20:23], v[120:135]
    ds_read_b64_tr_b16 v[44:45], v11 offset:10880
    ds_read_b64_tr_b16 v[46:47], v11 offset:11776
    s_waitcnt lgkmcnt(12)
    v_mfma_f32_32x32x16_bf16 v[136:151], v[48:51], v[20:23], v[136:151]
    ds_read_b64_tr_b16 v[48:49], v11 offset:10912
    ds_read_b64_tr_b16 v[50:51], v11 offset:11808
    s_waitcnt lgkmcnt(12)
    v_mfma_f32_32x32x16_bf16 v[152:167], v[52:55], v[20:23], v[152:167]
    ds_read_b64_tr_b16 v[52:53], v11 offset:10944
    ds_read_b64_tr_b16 v[54:55], v11 offset:11840
    s_add_u32 m0, s27, 35072
    s_nop 0
    buffer_load_dwordx4 v9, s[8:11], s34 offen lds
    buffer_load_dwordx4 v[20:23], v7, s[20:23], s35 offen offset:2048 sc1
    s_setprio 2
    s_mov_b64 exec, 2
    ds_add_u32 v7, v7 offset:64
    s_mov_b64 exec, 1
F_bb7:
    ds_read_b32 v1, v7 offset:80
    s_waitcnt lgkmcnt(0)
    v_readfirstlane_b32 s56, v1
    s_cmp_ge_u32 s56, 448
    s_cbranch_scc0 F_bb7
    s_mov_b64 exec, -1
    s_setprio 0
    s_waitcnt vmcnt(9)
    v_mfma_f32_32x32x16_bf16 v[56:71], v[28:31], v[24:27], v[56:71]
    ds_read_b64_tr_b16 v[28:29], v10 offset:0
    ds_read_b64_tr_b16 v[30:31], v10 offset:896
    v_mfma_f32_32x32x16_bf16 v[72:87], v[32:35], v[24:27], v[72:87]
    ds_read_b64_tr_b16 v[32:33], v10 offset:32
    ds_read_b64_tr_b16 v[34:35], v10 offset:928
    v_mfma_f32_32x32x16_bf16 v[88:103], v[36:39], v[24:27], v[88:103]
    ds_read_b64_tr_b16 v[36:37], v10 offset:64
    ds_read_b64_tr_b16 v[38:39], v10 offset:960
    v_mfma_f32_32x32x16_bf16 v[104:119], v[40:43], v[24:27], v[104:119]
    ds_read_b64_tr_b16 v[40:41], v10 offset:96
    ds_read_b64_tr_b16 v[42:43], v10 offset:992
    v_mfma_f32_32x32x16_bf16 v[120:135], v[44:47], v[24:27], v[120:135]
    ds_read_b64_tr_b16 v[44:45], v10 offset:128
    ds_read_b64_tr_b16 v[46:47], v10 offset:1024
    v_mfma_f32_32x32x16_bf16 v[136:151], v[48:51], v[24:27], v[136:151]
    ds_read_b64_tr_b16 v[48:49], v10 offset:160
    ds_read_b64_tr_b16 v[50:51], v10 offset:1056
    v_mfma_f32_32x32x16_bf16 v[152:167], v[52:55], v[24:27], v[152:167]
    ds_read_b64_tr_b16 v[52:53], v10 offset:192
    ds_read_b64_tr_b16 v[54:55], v10 offset:1088
    buffer_load_dwordx4 v[24:27], v7, s[20:23], s35 offen offset:3072 sc1
    s_waitcnt vmcnt(7)
    s_waitcnt lgkmcnt(12)
    v_mfma_f32_32x32x16_bf16 v[56:71], v[28:31], v[12:15], v[56:71]
    ds_read_b64_tr_b16 v[28:29], v10 offset:3584
    ds_read_b64_tr_b16 v[30:31], v10 offset:4480
    s_waitcnt lgkmcnt(12)
    v_mfma_f32_32x32x16_bf16 v[72:87], v[32:35], v[12:15], v[72:87]
    ds_read_b64_tr_b16 v[32:33], v10 offset:3616
    ds_read_b64_tr_b16 v[34:35], v10 offset:4512
    s_waitcnt lgkmcnt(12)
    v_mfma_f32_32x32x16_bf16 v[88:103], v[36:39], v[12:15], v[88:103]
    ds_read_b64_tr_b16 v[36:37], v10 offset:3648
    ds_read_b64_tr_b16 v[38:39], v10 offset:4544
    s_waitcnt lgkmcnt(12)
    v_mfma_f32_32x32x16_bf16 v[104:119], v[40:43], v[12:15], v[104:119]
    ds_read_b64_tr_b16 v[40:41], v10 offset:3680
    ds_read_b64_tr_b16 v[42:43], v10 offset:4576
    s_waitcnt lgkmcnt(12)
    v_mfma_f32_32x32x16_bf16 v[120:135], v[44:47], v[12:15], v[120:135]
    ds_read_b64_tr_b16 v[44:45], v10 offset:3712
    ds_read_b64_tr_b16 v[46:47], v10 offset:4608
    s_waitcnt lgkmcnt(12)
    v_mfma_f32_32x32x16_bf16 v[136:151], v[48:51], v[12:15], v[136:151]
    ds_read_b64_tr_b16 v[48:49], v10 offset:3744
    ds_read_b64_tr_b16 v[50:51], v10 offset:4640
    s_waitcnt lgkmcnt(12)
    v_mfma_f32_32x32x16_bf16 v[152:167], v[52:55], v[12:15], v[152:167]
    ds_read_b64_tr_b16 v[52:53], v10 offset:3776
    ds_read_b64_tr_b16 v[54:55], v10 offset:4672
    s_lshl_b32 s35, s31, 12
    s_add_u32 s35, s35, s33
    s_add_u32 s31, s31, 1
    s_and_b32 s31, s31, 7
    buffer_load_dwordx4 v[12:15], v7, s[20:23], s35 offen offset:0 sc1
    s_waitcnt vmcnt(5)
    s_waitcnt lgkmcnt(12)
    v_mfma_f32_32x32x16_bf16 v[56:71], v[28:31], v[16:19], v[56:71]
    ds_read_b64_tr_b16 v[28:29], v10 offset:7168
    ds_read_b64_tr_b16 v[30:31], v10 offset:8064
    s_waitcnt lgkmcnt(12)
    v_mfma_f32_32x32x16_bf16 v[72:87], v[32:35], v[16:19], v[72:87]
    ds_read_b64_tr_b16 v[32:33], v10 offset:7200
    ds_read_b64_tr_b16 v[34:35], v10 offset:8096
    s_waitcnt lgkmcnt(12)
    v_mfma_f32_32x32x16_bf16 v[88:103], v[36:39], v[16:19], v[88:103]
    ds_read_b64_tr_b16 v[36:37], v10 offset:7232
    ds_read_b64_tr_b16 v[38:39], v10 offset:8128
    s_waitcnt lgkmcnt(12)
    v_mfma_f32_32x32x16_bf16 v[104:119], v[40:43], v[16:19], v[104:119]
    ds_read_b64_tr_b16 v[40:41], v10 offset:7264
    ds_read_b64_tr_b16 v[42:43], v10 offset:8160
    s_waitcnt lgkmcnt(12)
    v_mfma_f32_32x32x16_bf16 v[120:135], v[44:47], v[16:19], v[120:135]
    ds_read_b64_tr_b16 v[44:45], v10 offset:7296
    ds_read_b64_tr_b16 v[46:47], v10 offset:8192
    s_waitcnt lgkmcnt(12)
    v_mfma_f32_32x32x16_bf16 v[136:151], v[48:51], v[16:19], v[136:151]
    ds_read_b64_tr_b16 v[48:49], v10 offset:7328
    ds_read_b64_tr_b16 v[50:51], v10 offset:8224
    s_waitcnt lgkmcnt(12)
    v_mfma_f32_32x32x16_bf16 v[152:167], v[52:55], v[16:19], v[152:167]
    ds_read_b64_tr_b16 v[52:53], v10 offset:7360
    ds_read_b64_tr_b16 v[54:55], v10 offset:8256
    buffer_load_dwordx4 v[16:19], v7, s[20:23], s35 offen offset:1024 sc1
    s_waitcnt vmcnt(3)
    s_waitcnt lgkmcnt(12)
    v_mfma_f32_32x32x16_bf16 v[56:71], v[28:31], v[20:23], v[56:71]
    ds_read_b64_tr_b16 v[28:29], v10 offset:10752
    ds_read_b64_tr_b16 v[30:31], v10 offset:11648
    s_waitcnt lgkmcnt(12)
    v_mfma_f32_32x32x16_bf16 v[72:87], v[32:35], v[20:23], v[72:87]
    ds_read_b64_tr_b16 v[32:33], v10 offset:10784
    ds_read_b64_tr_b16 v[34:35], v10 offset:11680
    s_waitcnt lgkmcnt(12)
    v_mfma_f32_32x32x16_bf16 v[88:103], v[36:39], v[20:23], v[88:103]
    ds_read_b64_tr_b16 v[36:37], v10 offset:10816
    ds_read_b64_tr_b16 v[38:39], v10 offset:11712
    s_waitcnt lgkmcnt(12)
    v_mfma_f32_32x32x16_bf16 v[104:119], v[40:43], v[20:23], v[104:119]
    ds_read_b64_tr_b16 v[40:41], v10 offset:10848
    ds_read_b64_tr_b16 v[42:43], v10 offset:11744
    s_waitcnt lgkmcnt(12)
    v_mfma_f32_32x32x16_bf16 v[120:135], v[44:47], v[20:23], v[120:135]
    ds_read_b64_tr_b16 v[44:45], v10 offset:10880
    ds_read_b64_tr_b16 v[46:47], v10 offset:11776
    s_waitcnt lgkmcnt(12)
    v_mfma_f32_32x32x16_bf16 v[136:151], v[48:51], v[20:23], v[136:151]
    ds_read_b64_tr_b16 v[48:49], v10 offset:10912
    ds_read_b64_tr_b16 v[50:51], v10 offset:11808
    s_waitcnt lgkmcnt(12)
    v_mfma_f32_32x32x16_bf16 v[152:167], v[52:55], v[20:23], v[152:167]
    ds_read_b64_tr_b16 v[52:53], v10 offset:10944
    ds_read_b64_tr_b16 v[54:55], v10 offset:11840
    buffer_load_dwordx4 v[20:23], v7, s[20:23], s35 offen offset:2048 sc1
    s_setprio 2
    s_mov_b64 exec, 2
    ds_add_u32 v7, v7 offset:64
    s_mov_b64 exec, 1
F_bb8:
    ds_read_b32 v1, v7 offset:80
    s_waitcnt lgkmcnt(0)
    v_readfirstlane_b32 s56, v1
    s_cmp_ge_u32 s56, 512
    s_cbranch_scc0 F_bb8
    s_mov_b64 exec, -1
    s_setprio 0
    s_waitcnt vmcnt(3)
    v_mfma_f32_32x32x16_bf16 v[56:71], v[28:31], v[24:27], v[56:71]
    ds_read_b64_tr_b16 v[28:29], v10 offset:28928
    ds_read_b64_tr_b16 v[30:31], v10 offset:29824
    v_mfma_f32_32x32x16_bf16 v[72:87], v[32:35], v[24:27], v[72:87]
    ds_read_b64_tr_b16 v[32:33], v10 offset:28960
    ds_read_b64_tr_b16 v[34:35], v10 offset:29856
    v_mfma_f32_32x32x16_bf16 v[88:103], v[36:39], v[24:27], v[88:103]
    ds_read_b64_tr_b16 v[36:37], v10 offset:28992
    ds_read_b64_tr_b16 v[38:39], v10 offset:29888
    v_mfma_f32_32x32x16_bf16 v[104:119], v[40:43], v[24:27], v[104:119]
    ds_read_b64_tr_b16 v[40:41], v10 offset:29024
    ds_read_b64_tr_b16 v[42:43], v10 offset:29920
    v_mfma_f32_32x32x16_bf16 v[120:135], v[44:47], v[24:27], v[120:135]
    ds_read_b64_tr_b16 v[44:45], v10 offset:29056
    ds_read_b64_tr_b16 v[46:47], v10 offset:29952
    v_mfma_f32_32x32x16_bf16 v[136:151], v[48:51], v[24:27], v[136:151]
    ds_read_b64_tr_b16 v[48:49], v10 offset:29088
    ds_read_b64_tr_b16 v[50:51], v10 offset:29984
    v_mfma_f32_32x32x16_bf16 v[152:167], v[52:55], v[24:27], v[152:167]
    ds_read_b64_tr_b16 v[52:53], v10 offset:29120
    ds_read_b64_tr_b16 v[54:55], v10 offset:30016
    buffer_load_dwordx4 v[24:27], v7, s[20:23], s35 offen offset:3072 sc1
    s_waitcnt vmcnt(3)
    s_waitcnt lgkmcnt(12)
    v_mfma_f32_32x32x16_bf16 v[56:71], v[28:31], v[12:15], v[56:71]
    ds_read_b64_tr_b16 v[28:29], v10 offset:32512
    ds_read_b64_tr_b16 v[30:31], v10 offset:33408
    s_waitcnt lgkmcnt(12)
    v_mfma_f32_32x32x16_bf16 v[72:87], v[32:35], v[12:15], v[72:87]
    ds_read_b64_tr_b16 v[32:33], v10 offset:32544
    ds_read_b64_tr_b16 v[34:35], v10 offset:33440
    s_waitcnt lgkmcnt(12)
    v_mfma_f32_32x32x16_bf16 v[88:103], v[36:39], v[12:15], v[88:103]
    ds_read_b64_tr_b16 v[36:37], v10 offset:32576
    ds_read_b64_tr_b16 v[38:39], v10 offset:33472
    s_waitcnt lgkmcnt(12)
    v_mfma_f32_32x32x16_bf16 v[104:119], v[40:43], v[12:15], v[104:119]
    ds_read_b64_tr_b16 v[40:41], v10 offset:32608
    ds_read_b64_tr_b16 v[42:43], v10 offset:33504
    s_waitcnt lgkmcnt(12)
    v_mfma_f32_32x32x16_bf16 v[120:135], v[44:47], v[12:15], v[120:135]
    ds_read_b64_tr_b16 v[44:45], v10 offset:32640
    ds_read_b64_tr_b16 v[46:47], v10 offset:33536
    s_waitcnt lgkmcnt(12)
    v_mfma_f32_32x32x16_bf16 v[136:151], v[48:51], v[12:15], v[136:151]
    ds_read_b64_tr_b16 v[48:49], v10 offset:32672
    ds_read_b64_tr_b16 v[50:51], v10 offset:33568
    s_waitcnt lgkmcnt(12)
    v_mfma_f32_32x32x16_bf16 v[152:167], v[52:55], v[12:15], v[152:167]
    ds_read_b64_tr_b16 v[52:53], v10 offset:32704
    ds_read_b64_tr_b16 v[54:55], v10 offset:33600
    s_waitcnt vmcnt(2)
    s_waitcnt lgkmcnt(12)
    v_mfma_f32_32x32x16_bf16 v[56:71], v[28:31], v[16:19], v[56:71]
    ds_read_b64_tr_b16 v[28:29], v10 offset:36096
    ds_read_b64_tr_b16 v[30:31], v10 offset:36992
    s_waitcnt lgkmcnt(12)
    v_mfma_f32_32x32x16_bf16 v[72:87], v[32:35], v[16:19], v[72:87]
    ds_read_b64_tr_b16 v[32:33], v10 offset:36128
    ds_read_b64_tr_b16 v[34:35], v10 offset:37024
    s_waitcnt lgkmcnt(12)
    v_mfma_f32_32x32x16_bf16 v[88:103], v[36:39], v[16:19], v[88:103]
    ds_read_b64_tr_b16 v[36:37], v10 offset:36160
    ds_read_b64_tr_b16 v[38:39], v10 offset:37056
    s_waitcnt lgkmcnt(12)
    v_mfma_f32_32x32x16_bf16 v[104:119], v[40:43], v[16:19], v[104:119]
    ds_read_b64_tr_b16 v[40:41], v10 offset:36192
    ds_read_b64_tr_b16 v[42:43], v10 offset:37088
    s_waitcnt lgkmcnt(12)
    v_mfma_f32_32x32x16_bf16 v[120:135], v[44:47], v[16:19], v[120:135]
    ds_read_b64_tr_b16 v[44:45], v10 offset:36224
    ds_read_b64_tr_b16 v[46:47], v10 offset:37120
    s_waitcnt lgkmcnt(12)
    v_mfma_f32_32x32x16_bf16 v[136:151], v[48:51], v[16:19], v[136:151]
    ds_read_b64_tr_b16 v[48:49], v10 offset:36256
    ds_read_b64_tr_b16 v[50:51], v10 offset:37152
    s_waitcnt lgkmcnt(12)
    v_mfma_f32_32x32x16_bf16 v[152:167], v[52:55], v[16:19], v[152:167]
    ds_read_b64_tr_b16 v[52:53], v10 offset:36288
    ds_read_b64_tr_b16 v[54:55], v10 offset:37184
    s_waitcnt vmcnt(1)
    s_waitcnt lgkmcnt(12)
    v_mfma_f32_32x32x16_bf16 v[56:71], v[28:31], v[20:23], v[56:71]
    ds_read_b64_tr_b16 v[28:29], v10 offset:39680
    ds_read_b64_tr_b16 v[30:31], v10 offset:40576
    s_waitcnt lgkmcnt(12)
    v_mfma_f32_32x32x16_bf16 v[72:87], v[32:35], v[20:23], v[72:87]
    ds_read_b64_tr_b16 v[32:33], v10 offset:39712
    ds_read_b64_tr_b16 v[34:35], v10 offset:40608
    s_waitcnt lgkmcnt(12)
    v_mfma_f32_32x32x16_bf16 v[88:103], v[36:39], v[20:23], v[88:103]
    ds_read_b64_tr_b16 v[36:37], v10 offset:39744
    ds_read_b64_tr_b16 v[38:39], v10 offset:40640
    s_waitcnt lgkmcnt(12)
    v_mfma_f32_32x32x16_bf16 v[104:119], v[40:43], v[20:23], v[104:119]
    ds_read_b64_tr_b16 v[40:41], v10 offset:39776
    ds_read_b64_tr_b16 v[42:43], v10 offset:40672
    s_waitcnt lgkmcnt(12)
    v_mfma_f32_32x32x16_bf16 v[120:135], v[44:47], v[20:23], v[120:135]
    ds_read_b64_tr_b16 v[44:45], v10 offset:39808
    ds_read_b64_tr_b16 v[46:47], v10 offset:40704
    s_waitcnt lgkmcnt(12)
    v_mfma_f32_32x32x16_bf16 v[136:151], v[48:51], v[20:23], v[136:151]
    ds_read_b64_tr_b16 v[48:49], v10 offset:39840
    ds_read_b64_tr_b16 v[50:51], v10 offset:40736
    s_waitcnt lgkmcnt(12)
    v_mfma_f32_32x32x16_bf16 v[152:167], v[52:55], v[20:23], v[152:167]
    ds_read_b64_tr_b16 v[52:53], v10 offset:39872
    ds_read_b64_tr_b16 v[54:55], v10 offset:40768
    s_waitcnt vmcnt(0)
    s_waitcnt lgkmcnt(12)
    v_mfma_f32_32x32x16_bf16 v[56:71], v[28:31], v[24:27], v[56:71]
    s_waitcnt lgkmcnt(10)
    v_mfma_f32_32x32x16_bf16 v[72:87], v[32:35], v[24:27], v[72:87]
    s_waitcnt lgkmcnt(8)
    v_mfma_f32_32x32x16_bf16 v[88:103], v[36:39], v[24:27], v[88:103]
    s_waitcnt lgkmcnt(6)
    v_mfma_f32_32x32x16_bf16 v[104:119], v[40:43], v[24:27], v[104:119]
    s_waitcnt lgkmcnt(4)
    v_mfma_f32_32x32x16_bf16 v[120:135], v[44:47], v[24:27], v[120:135]
    s_waitcnt lgkmcnt(2)
    v_mfma_f32_32x32x16_bf16 v[136:151], v[48:51], v[24:27], v[136:151]
    s_waitcnt lgkmcnt(0)
    v_mfma_f32_32x32x16_bf16 v[152:167], v[52:55], v[24:27], v[152:167]
    s_setprio 2
    s_mul_i32 s34, s32, 112
    s_mul_i32 s35, s25, 7
    s_add_u32 s34, s34, s35
    s_lshl_b32 s34, s34, 10
    s_add_u32 s34, s34, 8388608
    s_add_u32 s35, s34, 4096
    v_mov_b32 v1, 0xbfb8aa3b
    v_mul_f32 v56, v1, v56
    v_mul_f32 v57, v1, v57
    v_mul_f32 v58, v1, v58
    v_mul_f32 v59, v1, v59
    v_mul_f32 v60, v1, v60
    v_mul_f32 v61, v1, v61
    v_mul_f32 v62, v1, v62
    v_mul_f32 v63, v1, v63
    v_exp_f32 v56, v56
    v_exp_f32 v57, v57
    v_exp_f32 v58, v58
    v_exp_f32 v59, v59
    v_exp_f32 v60, v60
    v_exp_f32 v61, v61
    v_exp_f32 v62, v62
    v_exp_f32 v63, v63
    v_add_f32 v56, 1.0, v56
    v_add_f32 v57, 1.0, v57
    v_add_f32 v58, 1.0, v58
    v_add_f32 v59, 1.0, v59
    v_add_f32 v60, 1.0, v60
    v_add_f32 v61, 1.0, v61
    v_add_f32 v62, 1.0, v62
    v_add_f32 v63, 1.0, v63
    v_rcp_f32 v56, v56
    v_rcp_f32 v57, v57
    v_rcp_f32 v58, v58
    v_rcp_f32 v59, v59
    v_rcp_f32 v60, v60
    v_rcp_f32 v61, v61
    v_rcp_f32 v62, v62
    v_rcp_f32 v63, v63
    v_mul_f32 v56, v56, v64
    v_mul_f32 v57, v57, v65
    v_mul_f32 v58, v58, v66
    v_mul_f32 v59, v59, v67
    v_mul_f32 v60, v60, v68
    v_mul_f32 v61, v61, v69
    v_mul_f32 v62, v62, v70
    v_mul_f32 v63, v63, v71
    v_cvt_pk_bf16_f32 v64, v56, v57
    v_cvt_pk_bf16_f32 v65, v58, v59
    v_cvt_pk_bf16_f32 v66, v60, v61
    v_cvt_pk_bf16_f32 v67, v62, v63
    buffer_store_dwordx4 v[64:67], v7, s[20:23], s34 offen offset:0 sc1
    v_mul_f32 v72, v1, v72
    v_mul_f32 v73, v1, v73
    v_mul_f32 v74, v1, v74
    v_mul_f32 v75, v1, v75
    v_mul_f32 v76, v1, v76
    v_mul_f32 v77, v1, v77
    v_mul_f32 v78, v1, v78
    v_mul_f32 v79, v1, v79
    v_exp_f32 v72, v72
    v_exp_f32 v73, v73
    v_exp_f32 v74, v74
    v_exp_f32 v75, v75
    v_exp_f32 v76, v76
    v_exp_f32 v77, v77
    v_exp_f32 v78, v78
    v_exp_f32 v79, v79
    v_add_f32 v72, 1.0, v72
    v_add_f32 v73, 1.0, v73
    v_add_f32 v74, 1.0, v74
    v_add_f32 v75, 1.0, v75
    v_add_f32 v76, 1.0, v76
    v_add_f32 v77, 1.0, v77
    v_add_f32 v78, 1.0, v78
    v_add_f32 v79, 1.0, v79
    v_rcp_f32 v72, v72
    v_rcp_f32 v73, v73
    v_rcp_f32 v74, v74
    v_rcp_f32 v75, v75
    v_rcp_f32 v76, v76
    v_rcp_f32 v77, v77
    v_rcp_f32 v78, v78
    v_rcp_f32 v79, v79
    v_mul_f32 v72, v72, v80
    v_mul_f32 v73, v73, v81
    v_mul_f32 v74, v74, v82
    v_mul_f32 v75, v75, v83
    v_mul_f32 v76, v76, v84
    v_mul_f32 v77, v77, v85
    v_mul_f32 v78, v78, v86
    v_mul_f32 v79, v79, v87
    v_cvt_pk_bf16_f32 v80, v72, v73
    v_cvt_pk_bf16_f32 v81, v74, v75
    v_cvt_pk_bf16_f32 v82, v76, v77
    v_cvt_pk_bf16_f32 v83, v78, v79
    buffer_store_dwordx4 v[80:83], v7, s[20:23], s34 offen offset:1024 sc1
    v_mul_f32 v88, v1, v88
    v_mul_f32 v89, v1, v89
    v_mul_f32 v90, v1, v90
    v_mul_f32 v91, v1, v91
    v_mul_f32 v92, v1, v92
    v_mul_f32 v93, v1, v93
    v_mul_f32 v94, v1, v94
    v_mul_f32 v95, v1, v95
    v_exp_f32 v88, v88
    v_exp_f32 v89, v89
    v_exp_f32 v90, v90
    v_exp_f32 v91, v91
    v_exp_f32 v92, v92
    v_exp_f32 v93, v93
    v_exp_f32 v94, v94
    v_exp_f32 v95, v95
    v_add_f32 v88, 1.0, v88
    v_add_f32 v89, 1.0, v89
    v_add_f32 v90, 1.0, v90
    v_add_f32 v91, 1.0, v91
    v_add_f32 v92, 1.0, v92
    v_add_f32 v93, 1.0, v93
    v_add_f32 v94, 1.0, v94
    v_add_f32 v95, 1.0, v95
    v_rcp_f32 v88, v88
    v_rcp_f32 v89, v89
    v_rcp_f32 v90, v90
    v_rcp_f32 v91, v91
    v_rcp_f32 v92, v92
    v_rcp_f32 v93, v93
    v_rcp_f32 v94, v94
    v_rcp_f32 v95, v95
    v_mul_f32 v88, v88, v96
    v_mul_f32 v89, v89, v97
    v_mul_f32 v90, v90, v98
    v_mul_f32 v91, v91, v99
    v_mul_f32 v92, v92, v100
    v_mul_f32 v93, v93, v101
    v_mul_f32 v94, v94, v102
    v_mul_f32 v95, v95, v103
    v_cvt_pk_bf16_f32 v96, v88, v89
    v_cvt_pk_bf16_f32 v97, v90, v91
    v_cvt_pk_bf16_f32 v98, v92, v93
    v_cvt_pk_bf16_f32 v99, v94, v95
    buffer_store_dwordx4 v[96:99], v7, s[20:23], s34 offen offset:2048 sc1
    v_mul_f32 v104, v1, v104
    v_mul_f32 v105, v1, v105
    v_mul_f32 v106, v1, v106
    v_mul_f32 v107, v1, v107
    v_mul_f32 v108, v1, v108
    v_mul_f32 v109, v1, v109
    v_mul_f32 v110, v1, v110
    v_mul_f32 v111, v1, v111
    v_exp_f32 v104, v104
    v_exp_f32 v105, v105
    v_exp_f32 v106, v106
    v_exp_f32 v107, v107
    v_exp_f32 v108, v108
    v_exp_f32 v109, v109
    v_exp_f32 v110, v110
    v_exp_f32 v111, v111
    v_add_f32 v104, 1.0, v104
    v_add_f32 v105, 1.0, v105
    v_add_f32 v106, 1.0, v106
    v_add_f32 v107, 1.0, v107
    v_add_f32 v108, 1.0, v108
    v_add_f32 v109, 1.0, v109
    v_add_f32 v110, 1.0, v110
    v_add_f32 v111, 1.0, v111
    v_rcp_f32 v104, v104
    v_rcp_f32 v105, v105
    v_rcp_f32 v106, v106
    v_rcp_f32 v107, v107
    v_rcp_f32 v108, v108
    v_rcp_f32 v109, v109
    v_rcp_f32 v110, v110
    v_rcp_f32 v111, v111
    v_mul_f32 v104, v104, v112
    v_mul_f32 v105, v105, v113
    v_mul_f32 v106, v106, v114
    v_mul_f32 v107, v107, v115
    v_mul_f32 v108, v108, v116
    v_mul_f32 v109, v109, v117
    v_mul_f32 v110, v110, v118
    v_mul_f32 v111, v111, v119
    v_cvt_pk_bf16_f32 v112, v104, v105
    v_cvt_pk_bf16_f32 v113, v106, v107
    v_cvt_pk_bf16_f32 v114, v108, v109
    v_cvt_pk_bf16_f32 v115, v110, v111
    buffer_store_dwordx4 v[112:115], v7, s[20:23], s34 offen offset:3072 sc1
    v_mul_f32 v120, v1, v120
    v_mul_f32 v121, v1, v121
    v_mul_f32 v122, v1, v122
    v_mul_f32 v123, v1, v123
    v_mul_f32 v124, v1, v124
    v_mul_f32 v125, v1, v125
    v_mul_f32 v126, v1, v126
    v_mul_f32 v127, v1, v127
    v_exp_f32 v120, v120
    v_exp_f32 v121, v121
    v_exp_f32 v122, v122
    v_exp_f32 v123, v123
    v_exp_f32 v124, v124
    v_exp_f32 v125, v125
    v_exp_f32 v126, v126
    v_exp_f32 v127, v127
    v_add_f32 v120, 1.0, v120
    v_add_f32 v121, 1.0, v121
    v_add_f32 v122, 1.0, v122
    v_add_f32 v123, 1.0, v123
    v_add_f32 v124, 1.0, v124
    v_add_f32 v125, 1.0, v125
    v_add_f32 v126, 1.0, v126
    v_add_f32 v127, 1.0, v127
    v_rcp_f32 v120, v120
    v_rcp_f32 v121, v121
    v_rcp_f32 v122, v122
    v_rcp_f32 v123, v123
    v_rcp_f32 v124, v124
    v_rcp_f32 v125, v125
    v_rcp_f32 v126, v126
    v_rcp_f32 v127, v127
    v_mul_f32 v120, v120, v128
    v_mul_f32 v121, v121, v129
    v_mul_f32 v122, v122, v130
    v_mul_f32 v123, v123, v131
    v_mul_f32 v124, v124, v132
    v_mul_f32 v125, v125, v133
    v_mul_f32 v126, v126, v134
    v_mul_f32 v127, v127, v135
    v_cvt_pk_bf16_f32 v128, v120, v121
    v_cvt_pk_bf16_f32 v129, v122, v123
    v_cvt_pk_bf16_f32 v130, v124, v125
    v_cvt_pk_bf16_f32 v131, v126, v127
    buffer_store_dwordx4 v[128:131], v7, s[20:23], s35 offen offset:0 sc1
    v_mul_f32 v136, v1, v136
    v_mul_f32 v137, v1, v137
    v_mul_f32 v138, v1, v138
    v_mul_f32 v139, v1, v139
    v_mul_f32 v140, v1, v140
    v_mul_f32 v141, v1, v141
    v_mul_f32 v142, v1, v142
    v_mul_f32 v143, v1, v143
    v_exp_f32 v136, v136
    v_exp_f32 v137, v137
    v_exp_f32 v138, v138
    v_exp_f32 v139, v139
    v_exp_f32 v140, v140
    v_exp_f32 v141, v141
    v_exp_f32 v142, v142
    v_exp_f32 v143, v143
    v_add_f32 v136, 1.0, v136
    v_add_f32 v137, 1.0, v137
    v_add_f32 v138, 1.0, v138
    v_add_f32 v139, 1.0, v139
    v_add_f32 v140, 1.0, v140
    v_add_f32 v141, 1.0, v141
    v_add_f32 v142, 1.0, v142
    v_add_f32 v143, 1.0, v143
    v_rcp_f32 v136, v136
    v_rcp_f32 v137, v137
    v_rcp_f32 v138, v138
    v_rcp_f32 v139, v139
    v_rcp_f32 v140, v140
    v_rcp_f32 v141, v141
    v_rcp_f32 v142, v142
    v_rcp_f32 v143, v143
    v_mul_f32 v136, v136, v144
    v_mul_f32 v137, v137, v145
    v_mul_f32 v138, v138, v146
    v_mul_f32 v139, v139, v147
    v_mul_f32 v140, v140, v148
    v_mul_f32 v141, v141, v149
    v_mul_f32 v142, v142, v150
    v_mul_f32 v143, v143, v151
    v_cvt_pk_bf16_f32 v144, v136, v137
    v_cvt_pk_bf16_f32 v145, v138, v139
    v_cvt_pk_bf16_f32 v146, v140, v141
    v_cvt_pk_bf16_f32 v147, v142, v143
    buffer_store_dwordx4 v[144:147], v7, s[20:23], s35 offen offset:1024 sc1
    s_nop 3
    v_mul_f32 v152, v1, v152
    v_mul_f32 v153, v1, v153
    v_mul_f32 v154, v1, v154
    v_mul_f32 v155, v1, v155
    v_mul_f32 v156, v1, v156
    v_mul_f32 v157, v1, v157
    v_mul_f32 v158, v1, v158
    v_mul_f32 v159, v1, v159
    v_exp_f32 v152, v152
    v_exp_f32 v153, v153
    v_exp_f32 v154, v154
    v_exp_f32 v155, v155
    v_exp_f32 v156, v156
    v_exp_f32 v157, v157
    v_exp_f32 v158, v158
    v_exp_f32 v159, v159
    v_add_f32 v152, 1.0, v152
    v_add_f32 v153, 1.0, v153
    v_add_f32 v154, 1.0, v154
    v_add_f32 v155, 1.0, v155
    v_add_f32 v156, 1.0, v156
    v_add_f32 v157, 1.0, v157
    v_add_f32 v158, 1.0, v158
    v_add_f32 v159, 1.0, v159
    v_rcp_f32 v152, v152
    v_rcp_f32 v153, v153
    v_rcp_f32 v154, v154
    v_rcp_f32 v155, v155
    v_rcp_f32 v156, v156
    v_rcp_f32 v157, v157
    v_rcp_f32 v158, v158
    v_rcp_f32 v159, v159
    v_mul_f32 v152, v152, v160
    v_mul_f32 v153, v153, v161
    v_mul_f32 v154, v154, v162
    v_mul_f32 v155, v155, v163
    v_mul_f32 v156, v156, v164
    v_mul_f32 v157, v157, v165
    v_mul_f32 v158, v158, v166
    v_mul_f32 v159, v159, v167
    v_cvt_pk_bf16_f32 v160, v152, v153
    v_cvt_pk_bf16_f32 v161, v154, v155
    v_cvt_pk_bf16_f32 v162, v156, v157
    v_cvt_pk_bf16_f32 v163, v158, v159
    buffer_store_dwordx4 v[160:163], v7, s[20:23], s35 offen offset:2048 sc1
    s_waitcnt vmcnt(0)
    s_mov_b64 exec, 2
    ds_add_u32 v7, v7 offset:64
    s_mov_b64 exec, 1
F_bb9:
    ds_read_b32 v1, v7 offset:80
    s_waitcnt lgkmcnt(0)
    v_readfirstlane_b32 s56, v1
    s_cmp_ge_u32 s56, 576
    s_cbranch_scc0 F_bb9
    s_mov_b64 exec, -1
    s_cmp_eq_u32 s3, 0
    s_cbranch_scc0 F_noflag
    s_lshl_b32 s34, s24, 4
    s_add_u32 s34, s34, s25
    s_lshl_b32 s34, s34, 7
    s_add_u32 s34, s34, 31522816
    v_mov_b32 v1, 0
    s_mov_b64 exec, 1
    v_mov_b32 v2, s68
    v_mov_b32 v3, s69
    buffer_store_dwordx2 v[2:3], v1, s[20:23], s34 offen sc1
    s_mov_b64 exec, -1
F_noflag:
    s_mov_b32 s4, s46
    s_mov_b32 s5, s47
    v_lshrrev_b32 v0, 4, v7
    s_and_b32 s24, s2, 3
    s_lshl_b32 s24, s24, 3
    s_bfe_u32 s25, s2, 0x30003
    s_add_u32 s24, s24, s25
    s_bfe_u32 s25, s2, 0x10002
    s_lshl_b32 s25, s25, 2
    s_lshr_b32 s26, s2, 6
    s_add_u32 s25, s25, s26
    s_mov_b32 s8, s4
    s_mov_b32 s9, s5
    s_mov_b32 s10, 1835008
    s_mov_b32 s11, 0x00020000
    v_lshrrev_b32 v1, 3, v0
    v_and_b32 v2, 7, v0
    v_bfe_u32 v3, v0, 4, 1
    v_lshlrev_b32 v3, 2, v3
    v_xor_b32 v2, v2, v3
    v_lshlrev_b32 v1, 10, v1
    v_lshl_add_u32 v8, v2, 4, v1
    s_lshl_b32 s26, s25, 7
    v_add_u32 v8, s26, v8
    v_add_u32 v9, 8192, v8
    s_mul_i32 s27, s3, 458752
    s_mul_i32 s28, s3, 17408
    s_add_u32 s28, s28, 256
    s_mul_i32 s29, s24, 229376
    s_mul_i32 s30, s3, 28672
    s_add_u32 s29, s29, s30
    s_add_u32 s29, s29, 8388608
    s_add_u32 s30, s29, 114688
    v_lshlrev_b32 v7, 4, v0
    v_lshrrev_b32 v1, 5, v0
    v_bfe_u32 v2, v0, 2, 2
    v_lshl_add_u32 v1, v1, 2, v2
    v_lshlrev_b32 v1, 7, v1
    v_bfe_u32 v3, v0, 4, 1
    v_lshlrev_b32 v3, 1, v3
    v_bfe_u32 v14, v0, 1, 1
    v_add_u32 v3, v3, v14
    v_bfe_u32 v14, v0, 3, 1
    v_lshl_add_u32 v3, v14, 2, v3
    v_lshl_add_u32 v1, v3, 4, v1
    v_and_b32 v14, 1, v0
    v_lshl_add_u32 v1, v14, 3, v1
    v_add_u32 v10, s28, v1
    v_xor_b32 v11, 64, v10
    s_add_u32 s31, s27, 0
    s_add_u32 m0, s28, 0
    s_nop 0
    buffer_load_dwordx4 v8, s[8:11], s31 offen lds
    s_add_u32 m0, s28, 1024
    s_nop 0
    buffer_load_dwordx4 v9, s[8:11], s31 offen lds
    s_add_u32 s31, s27, 16384
    s_add_u32 m0, s28, 2048
    s_nop 0
    buffer_load_dwordx4 v8, s[8:11], s31 offen lds
    s_add_u32 m0, s28, 3072
    s_nop 0
    buffer_load_dwordx4 v9, s[8:11], s31 offen lds
    s_add_u32 s31, s27, 32768
    s_add_u32 m0, s28, 4096
    s_nop 0
    buffer_load_dwordx4 v8, s[8:11], s31 offen lds
    s_add_u32 m0, s28, 5120
    s_nop 0
    buffer_load_dwordx4 v9, s[8:11], s31 offen lds
    s_add_u32 s31, s27, 49152
    s_add_u32 m0, s28, 6144
    s_nop 0
    buffer_load_dwordx4 v8, s[8:11], s31 offen lds
    s_add_u32 m0, s28, 7168
    s_nop 0
    buffer_load_dwordx4 v9, s[8:11], s31 offen lds
    s_add_u32 s31, s27, 65536
    s_add_u32 m0, s28, 8192
    s_nop 0
    buffer_load_dwordx4 v8, s[8:11], s31 offen lds
    s_add_u32 m0, s28, 9216
    s_nop 0
    buffer_load_dwordx4 v9, s[8:11], s31 offen lds
    s_add_u32 s31, s27, 81920
    s_add_u32 m0, s28, 10240
    s_nop 0
    buffer_load_dwordx4 v8, s[8:11], s31 offen lds
    s_add_u32 m0, s28, 11264
    s_nop 0
    buffer_load_dwordx4 v9, s[8:11], s31 offen lds
    s_lshr_b32 s34, s24, 1
    s_lshl_b32 s34, s34, 11
    s_lshl_b32 s35, s3, 9
    s_add_u32 s34, s34, s35
    s_add_u32 s34, s34, 31522816
    v_and_b32 v1, 3, v0
    v_lshlrev_b32 v1, 7, v1
Lq19:
    buffer_load_dwordx2 v[16:17], v1, s[20:23], s34 offen sc1
    s_waitcnt vmcnt(0)
    v_cmp_ne_u64 vcc, s[68:69], v[16:17]
    s_nop 1
    s_cmp_eq_u64 vcc, 0
    s_cbranch_scc1 Lq19x
    s_sleep 4
    s_branch Lq19
Lq19x:
    s_and_b32 s34, s25, 3
    s_mul_i32 s34, s34, 7168
    v_min_u32 v1, 55, v0
    v_lshlrev_b32 v1, 7, v1
    v_add_u32 v1, s34, v1
    buffer_load_dword v16, v1, s[20:23], s29 offen sc1
    buffer_load_dword v17, v1, s[20:23], s30 offen sc1
    s_waitcnt vmcnt(0)
    v_mov_b32 v1, 0
Lw20:
    ds_read_b32 v16, v1 offset:128
    s_waitcnt lgkmcnt(0)
    v_readfirstlane_b32 s35, v16
    s_cmp_ge_u32 s35, 13
    s_cbranch_scc1 Lw20x
    s_sleep 8
    s_branch Lw20
Lw20x:
    buffer_load_dwordx4 v[40:43], v7, s[20:23], s29 offen offset:0 sc1
    buffer_load_dwordx4 v[44:47], v7, s[20:23], s30 offen offset:0 sc1
    buffer_load_dwordx4 v[48:51], v7, s[20:23], s29 offen offset:1024 sc1
    buffer_load_dwordx4 v[52:55], v7, s[20:23], s30 offen offset:1024 sc1
    buffer_load_dwordx4 v[56:59], v7, s[20:23], s29 offen offset:2048 sc1
    buffer_load_dwordx4 v[60:63], v7, s[20:23], s30 offen offset:2048 sc1
    buffer_load_dwordx4 v[64:67], v7, s[20:23], s29 offen offset:3072 sc1
    buffer_load_dwordx4 v[68:71], v7, s[20:23], s30 offen offset:3072 sc1
    s_add_u32 s29, s29, 4096
    s_add_u32 s30, s30, 4096
    buffer_load_dwordx4 v[72:75], v7, s[20:23], s29 offen offset:0 sc1
    buffer_load_dwordx4 v[76:79], v7, s[20:23], s30 offen offset:0 sc1
    buffer_load_dwordx4 v[80:83], v7, s[20:23], s29 offen offset:1024 sc1
    buffer_load_dwordx4 v[84:87], v7, s[20:23], s30 offen offset:1024 sc1
    buffer_load_dwordx4 v[88:91], v7, s[20:23], s29 offen offset:2048 sc1
    buffer_load_dwordx4 v[92:95], v7, s[20:23], s30 offen offset:2048 sc1
    ds_read_b64_tr_b16 v[24:25], v10 offset:0
    ds_read_b64_tr_b16 v[26:27], v10 offset:1024
    ds_read_b64_tr_b16 v[28:29], v11 offset:0
    ds_read_b64_tr_b16 v[30:31], v11 offset:1024
    s_setprio 0
    ds_read_b64_tr_b16 v[32:33], v10 offset:2048
    ds_read_b64_tr_b16 v[34:35], v10 offset:3072
    ds_read_b64_tr_b16 v[36:37], v11 offset:2048
    ds_read_b64_tr_b16 v[38:39], v11 offset:3072
    s_waitcnt vmcnt(12)
    s_waitcnt lgkmcnt(6)
    v_mfma_f32_32x32x16_bf16 v[104:119], v[24:27], v[40:43], 0
    v_mfma_f32_32x32x16_bf16 v[136:151], v[24:27], v[44:47], 0
    s_waitcnt lgkmcnt(4)
    v_mfma_f32_32x32x16_bf16 v[120:135], v[28:31], v[40:43], 0
    v_mfma_f32_32x32x16_bf16 v[152:167], v[28:31], v[44:47], 0
    s_add_u32 s31, s27, 98304
    s_add_u32 m0, s28, 12288
    s_nop 0
    buffer_load_dwordx4 v8, s[8:11], s31 offen lds
    s_add_u32 m0, s28, 13312
    s_nop 0
    buffer_load_dwordx4 v9, s[8:11], s31 offen lds
    buffer_load_dwordx4 v[40:43], v7, s[20:23], s29 offen offset:3072 sc1
    buffer_load_dwordx4 v[44:47], v7, s[20:23], s30 offen offset:3072 sc1
    ds_read_b64_tr_b16 v[24:25], v10 offset:4096
    ds_read_b64_tr_b16 v[26:27], v10 offset:5120
    ds_read_b64_tr_b16 v[28:29], v11 offset:4096
    ds_read_b64_tr_b16 v[30:31], v11 offset:5120
    s_waitcnt vmcnt(14)
    s_waitcnt lgkmcnt(6)
    v_mfma_f32_32x32x16_bf16 v[104:119], v[32:35], v[48:51], v[104:119]
    v_mfma_f32_32x32x16_bf16 v[136:151], v[32:35], v[52:55], v[136:151]
    s_waitcnt lgkmcnt(4)
    v_mfma_f32_32x32x16_bf16 v[120:135], v[36:39], v[48:51], v[120:135]
    v_mfma_f32_32x32x16_bf16 v[152:167], v[36:39], v[52:55], v[152:167]
    s_add_u32 s31, s27, 114688
    s_add_u32 m0, s28, 0
    s_nop 0
    buffer_load_dwordx4 v8, s[8:11], s31 offen lds
    s_add_u32 m0, s28, 1024
    s_nop 0
    buffer_load_dwordx4 v9, s[8:11], s31 offen lds
    s_add_u32 s29, s29, 4096
    s_add_u32 s30, s30, 4096
    buffer_load_dwordx4 v[48:51], v7, s[20:23], s29 offen offset:0 sc1
    buffer_load_dwordx4 v[52:55], v7, s[20:23], s30 offen offset:0 sc1
    ds_read_b64_tr_b16 v[32:33], v10 offset:6144
    ds_read_b64_tr_b16 v[34:35], v10 offset:7168
    ds_read_b64_tr_b16 v[36:37], v11 offset:6144
    ds_read_b64_tr_b16 v[38:39], v11 offset:7168
    s_waitcnt vmcnt(16)
    s_waitcnt lgkmcnt(6)
    v_mfma_f32_32x32x16_bf16 v[104:119], v[24:27], v[56:59], v[104:119]
    v_mfma_f32_32x32x16_bf16 v[136:151], v[24:27], v[60:63], v[136:151]
    s_waitcnt lgkmcnt(4)
    v_mfma_f32_32x32x16_bf16 v[120:135], v[28:31], v[56:59], v[120:135]
    v_mfma_f32_32x32x16_bf16 v[152:167], v[28:31], v[60:63], v[152:167]
    s_add_u32 s31, s27, 131072
    s_add_u32 m0, s28, 2048
    s_nop 0
    buffer_load_dwordx4 v8, s[8:11], s31 offen lds
    s_add_u32 m0, s28, 3072
    s_nop 0
    buffer_load_dwordx4 v9, s[8:11], s31 offen lds
    buffer_load_dwordx4 v[56:59], v7, s[20:23], s29 offen offset:1024 sc1
    buffer_load_dwordx4 v[60:63], v7, s[20:23], s30 offen offset:1024 sc1
    ds_read_b64_tr_b16 v[24:25], v10 offset:8192
    ds_read_b64_tr_b16 v[26:27], v10 offset:9216
    ds_read_b64_tr_b16 v[28:29], v11 offset:8192
    ds_read_b64_tr_b16 v[30:31], v11 offset:9216
    s_waitcnt vmcnt(18)
    s_waitcnt lgkmcnt(6)
    v_mfma_f32_32x32x16_bf16 v[104:119], v[32:35], v[64:67], v[104:119]
    v_mfma_f32_32x32x16_bf16 v[136:151], v[32:35], v[68:71], v[136:151]
    s_waitcnt lgkmcnt(4)
    v_mfma_f32_32x32x16_bf16 v[120:135], v[36:39], v[64:67], v[120:135]
    v_mfma_f32_32x32x16_bf16 v[152:167], v[36:39], v[68:71], v[152:167]
    s_add_u32 s31, s27, 147456
    s_add_u32 m0, s28, 4096
    s_nop 0
    buffer_load_dwordx4 v8, s[8:11], s31 offen lds
    s_add_u32 m0, s28, 5120
    s_nop 0
    buffer_load_dwordx4 v9, s[8:11], s31 offen lds
    buffer_load_dwordx4 v[64:67], v7, s[20:23], s29 offen offset:2048 sc1
    buffer_load_dwordx4 v[68:71], v7, s[20:23], s30 offen offset:2048 sc1
    ds_read_b64_tr_b16 v[32:33], v10 offset:10240
    ds_read_b64_tr_b16 v[34:35], v10 offset:11264
    ds_read_b64_tr_b16 v[36:37], v11 offset:10240
    ds_read_b64_tr_b16 v[38:39], v11 offset:11264
    s_waitcnt vmcnt(20)
    s_waitcnt lgkmcnt(6)
    v_mfma_f32_32x32x16_bf16 v[104:119], v[24:27], v[72:75], v[104:119]
    v_mfma_f32_32x32x16_bf16 v[136:151], v[24:27], v[76:79], v[136:151]
    s_waitcnt lgkmcnt(4)
    v_mfma_f32_32x32x16_bf16 v[120:135], v[28:31], v[72:75], v[120:135]
    v_mfma_f32_32x32x16_bf16 v[152:167], v[28:31], v[76:79], v[152:167]
    s_add_u32 s31, s27, 163840
    s_add_u32 m0, s28, 6144
    s_nop 0
    buffer_load_dwordx4 v8, s[8:11], s31 offen lds
    s_add_u32 m0, s28, 7168
    s_nop 0
    buffer_load_dwordx4 v9, s[8:11], s31 offen lds
    buffer_load_dwordx4 v[72:75], v7, s[20:23], s29 offen offset:3072 sc1
    buffer_load_dwordx4 v[76:79], v7, s[20:23], s30 offen offset:3072 sc1
    s_waitcnt vmcnt(18)
    ds_read_b64_tr_b16 v[24:25], v10 offset:12288
    ds_read_b64_tr_b16 v[26:27], v10 offset:13312
    ds_read_b64_tr_b16 v[28:29], v11 offset:12288
    ds_read_b64_tr_b16 v[30:31], v11 offset:13312
    s_waitcnt lgkmcnt(6)
    v_mfma_f32_32x32x16_bf16 v[104:119], v[32:35], v[80:83], v[104:119]
    v_mfma_f32_32x32x16_bf16 v[136:151], v[32:35], v[84:87], v[136:151]
    s_waitcnt lgkmcnt(4)
    v_mfma_f32_32x32x16_bf16 v[120:135], v[36:39], v[80:83], v[120:135]
    v_mfma_f32_32x32x16_bf16 v[152:167], v[36:39], v[84:87], v[152:167]
    s_add_u32 s31, s27, 180224
    s_add_u32 m0, s28, 8192
    s_nop 0
    buffer_load_dwordx4 v8, s[8:11], s31 offen lds
    s_add_u32 m0, s28, 9216
    s_nop 0
    buffer_load_dwordx4 v9, s[8:11], s31 offen lds
    s_add_u32 s29, s29, 4096
    s_add_u32 s30, s30, 4096
    buffer_load_dwordx4 v[80:83], v7, s[20:23], s29 offen offset:0 sc1
    buffer_load_dwordx4 v[84:87], v7, s[20:23], s30 offen offset:0 sc1
    s_waitcnt vmcnt(18)
    ds_read_b64_tr_b16 v[32:33], v10 offset:0
    ds_read_b64_tr_b16 v[34:35], v10 offset:1024
    ds_read_b64_tr_b16 v[36:37], v11 offset:0
    ds_read_b64_tr_b16 v[38:39], v11 offset:1024
    s_waitcnt lgkmcnt(6)
    v_mfma_f32_32x32x16_bf16 v[104:119], v[24:27], v[88:91], v[104:119]
    v_mfma_f32_32x32x16_bf16 v[136:151], v[24:27], v[92:95], v[136:151]
    s_waitcnt lgkmcnt(4)
    v_mfma_f32_32x32x16_bf16 v[120:135], v[28:31], v[88:91], v[120:135]
    v_mfma_f32_32x32x16_bf16 v[152:167], v[28:31], v[92:95], v[152:167]
    s_add_u32 s31, s27, 196608
    s_add_u32 m0, s28, 10240
    s_nop 0
    buffer_load_dwordx4 v8, s[8:11], s31 offen lds
    s_add_u32 m0, s28, 11264
    s_nop 0
    buffer_load_dwordx4 v9, s[8:11], s31 offen lds
    buffer_load_dwordx4 v[88:91], v7, s[20:23], s29 offen offset:1024 sc1
    buffer_load_dwordx4 v[92:95], v7, s[20:23], s30 offen offset:1024 sc1
    s_waitcnt vmcnt(18)
    ds_read_b64_tr_b16 v[24:25], v10 offset:2048
    ds_read_b64_tr_b16 v[26:27], v10 offset:3072
    ds_read_b64_tr_b16 v[28:29], v11 offset:2048
    ds_read_b64_tr_b16 v[30:31], v11 offset:3072
    s_waitcnt lgkmcnt(6)
    v_mfma_f32_32x32x16_bf16 v[104:119], v[32:35], v[40:43], v[104:119]
    v_mfma_f32_32x32x16_bf16 v[136:151], v[32:35], v[44:47], v[136:151]
    s_waitcnt lgkmcnt(4)
    v_mfma_f32_32x32x16_bf16 v[120:135], v[36:39], v[40:43], v[120:135]
    v_mfma_f32_32x32x16_bf16 v[152:167], v[36:39], v[44:47], v[152:167]
    s_add_u32 s31, s27, 212992
    s_add_u32 m0, s28, 12288
    s_nop 0
    buffer_load_dwordx4 v8, s[8:11], s31 offen lds
    s_add_u32 m0, s28, 13312
    s_nop 0
    buffer_load_dwordx4 v9, s[8:11], s31 offen lds
    buffer_load_dwordx4 v[40:43], v7, s[20:23], s29 offen offset:2048 sc1
    buffer_load_dwordx4 v[44:47], v7, s[20:23], s30 offen offset:2048 sc1
    s_waitcnt vmcnt(18)
    ds_read_b64_tr_b16 v[32:33], v10 offset:4096
    ds_read_b64_tr_b16 v[34:35], v10 offset:5120
    ds_read_b64_tr_b16 v[36:37], v11 offset:4096
    ds_read_b64_tr_b16 v[38:39], v11 offset:5120
    s_waitcnt lgkmcnt(6)
    v_mfma_f32_32x32x16_bf16 v[104:119], v[24:27], v[48:51], v[104:119]
    v_mfma_f32_32x32x16_bf16 v[136:151], v[24:27], v[52:55], v[136:151]
    s_waitcnt lgkmcnt(4)
    v_mfma_f32_32x32x16_bf16 v[120:135], v[28:31], v[48:51], v[120:135]
    v_mfma_f32_32x32x16_bf16 v[152:167], v[28:31], v[52:55], v[152:167]
    s_add_u32 s31, s27, 229376
    s_add_u32 m0, s28, 0
    s_nop 0
    buffer_load_dwordx4 v8, s[8:11], s31 offen lds
    s_add_u32 m0, s28, 1024
    s_nop 0
    buffer_load_dwordx4 v9, s[8:11], s31 offen lds
    buffer_load_dwordx4 v[48:51], v7, s[20:23], s29 offen offset:3072 sc1
    buffer_load_dwordx4 v[52:55], v7, s[20:23], s30 offen offset:3072 sc1
    s_waitcnt vmcnt(18)
    ds_read_b64_tr_b16 v[24:25], v10 offset:6144
    ds_read_b64_tr_b16 v[26:27], v10 offset:7168
    ds_read_b64_tr_b16 v[28:29], v11 offset:6144
    ds_read_b64_tr_b16 v[30:31], v11 offset:7168
    s_waitcnt lgkmcnt(6)
    v_mfma_f32_32x32x16_bf16 v[104:119], v[32:35], v[56:59], v[104:119]
    v_mfma_f32_32x32x16_bf16 v[136:151], v[32:35], v[60:63], v[136:151]
    s_waitcnt lgkmcnt(4)
    v_mfma_f32_32x32x16_bf16 v[120:135], v[36:39], v[56:59], v[120:135]
    v_mfma_f32_32x32x16_bf16 v[152:167], v[36:39], v[60:63], v[152:167]
    s_add_u32 s31, s27, 245760
    s_add_u32 m0, s28, 2048
    s_nop 0
    buffer_load_dwordx4 v8, s[8:11], s31 offen lds
    s_add_u32 m0, s28, 3072
    s_nop 0
    buffer_load_dwordx4 v9, s[8:11], s31 offen lds
    s_add_u32 s29, s29, 4096
    s_add_u32 s30, s30, 4096
    buffer_load_dwordx4 v[56:59], v7, s[20:23], s29 offen offset:0 sc1
    buffer_load_dwordx4 v[60:63], v7, s[20:23], s30 offen offset:0 sc1
    s_waitcnt vmcnt(18)
    ds_read_b64_tr_b16 v[32:33], v10 offset:8192
    ds_read_b64_tr_b16 v[34:35], v10 offset:9216
    ds_read_b64_tr_b16 v[36:37], v11 offset:8192
    ds_read_b64_tr_b16 v[38:39], v11 offset:9216
    s_waitcnt lgkmcnt(6)
    v_mfma_f32_32x32x16_bf16 v[104:119], v[24:27], v[64:67], v[104:119]
    v_mfma_f32_32x32x16_bf16 v[136:151], v[24:27], v[68:71], v[136:151]
    s_waitcnt lgkmcnt(4)
    v_mfma_f32_32x32x16_bf16 v[120:135], v[28:31], v[64:67], v[120:135]
    v_mfma_f32_32x32x16_bf16 v[152:167], v[28:31], v[68:71], v[152:167]
    s_add_u32 s31, s27, 262144
    s_add_u32 m0, s28, 4096
    s_nop 0
    buffer_load_dwordx4 v8, s[8:11], s31 offen lds
    s_add_u32 m0, s28, 5120
    s_nop 0
    buffer_load_dwordx4 v9, s[8:11], s31 offen lds
    buffer_load_dwordx4 v[64:67], v7, s[20:23], s29 offen offset:1024 sc1
    buffer_load_dwordx4 v[68:71], v7, s[20:23], s30 offen offset:1024 sc1
    s_waitcnt vmcnt(18)
    ds_read_b64_tr_b16 v[24:25], v10 offset:10240
    ds_read_b64_tr_b16 v[26:27], v10 offset:11264
    ds_read_b64_tr_b16 v[28:29], v11 offset:10240
    ds_read_b64_tr_b16 v[30:31], v11 offset:11264
    s_waitcnt lgkmcnt(6)
    v_mfma_f32_32x32x16_bf16 v[104:119], v[32:35], v[72:75], v[104:119]
    v_mfma_f32_32x32x16_bf16 v[136:151], v[32:35], v[76:79], v[136:151]
    s_waitcnt lgkmcnt(4)
    v_mfma_f32_32x32x16_bf16 v[120:135], v[36:39], v[72:75], v[120:135]
    v_mfma_f32_32x32x16_bf16 v[152:167], v[36:39], v[76:79], v[152:167]
    s_add_u32 s31, s27, 278528
    s_add_u32 m0, s28, 6144
    s_nop 0
    buffer_load_dwordx4 v8, s[8:11], s31 offen lds
    s_add_u32 m0, s28, 7168
    s_nop 0
    buffer_load_dwordx4 v9, s[8:11], s31 offen lds
    buffer_load_dwordx4 v[72:75], v7, s[20:23], s29 offen offset:2048 sc1
    buffer_load_dwordx4 v[76:79], v7, s[20:23], s30 offen offset:2048 sc1
    s_waitcnt vmcnt(18)
    ds_read_b64_tr_b16 v[32:33], v10 offset:12288
    ds_read_b64_tr_b16 v[34:35], v10 offset:13312
    ds_read_b64_tr_b16 v[36:37], v11 offset:12288
    ds_read_b64_tr_b16 v[38:39], v11 offset:13312
    s_waitcnt lgkmcnt(6)
    v_mfma_f32_32x32x16_bf16 v[104:119], v[24:27], v[80:83], v[104:119]
    v_mfma_f32_32x32x16_bf16 v[136:151], v[24:27], v[84:87], v[136:151]
    s_waitcnt lgkmcnt(4)
    v_mfma_f32_32x32x16_bf16 v[120:135], v[28:31], v[80:83], v[120:135]
    v_mfma_f32_32x32x16_bf16 v[152:167], v[28:31], v[84:87], v[152:167]
    s_add_u32 s31, s27, 294912
    s_add_u32 m0, s28, 8192
    s_nop 0
    buffer_load_dwordx4 v8, s[8:11], s31 offen lds
    s_add_u32 m0, s28, 9216
    s_nop 0
    buffer_load_dwordx4 v9, s[8:11], s31 offen lds
    buffer_load_dwordx4 v[80:83], v7, s[20:23], s29 offen offset:3072 sc1
    buffer_load_dwordx4 v[84:87], v7, s[20:23], s30 offen offset:3072 sc1
    s_waitcnt vmcnt(18)
    ds_read_b64_tr_b16 v[24:25], v10 offset:0
    ds_read_b64_tr_b16 v[26:27], v10 offset:1024
    ds_read_b64_tr_b16 v[28:29], v11 offset:0
    ds_read_b64_tr_b16 v[30:31], v11 offset:1024
    s_waitcnt lgkmcnt(6)
    v_mfma_f32_32x32x16_bf16 v[104:119], v[32:35], v[88:91], v[104:119]
    v_mfma_f32_32x32x16_bf16 v[136:151], v[32:35], v[92:95], v[136:151]
    s_waitcnt lgkmcnt(4)
    v_mfma_f32_32x32x16_bf16 v[120:135], v[36:39], v[88:91], v[120:135]
    v_mfma_f32_32x32x16_bf16 v[152:167], v[36:39], v[92:95], v[152:167]
    s_add_u32 s31, s27, 311296
    s_add_u32 m0, s28, 10240
    s_nop 0
    buffer_load_dwordx4 v8, s[8:11], s31 offen lds
    s_add_u32 m0, s28, 11264
    s_nop 0
    buffer_load_dwordx4 v9, s[8:11], s31 offen lds
    s_add_u32 s29, s29, 4096
    s_add_u32 s30, s30, 4096
    buffer_load_dwordx4 v[88:91], v7, s[20:23], s29 offen offset:0 sc1
    buffer_load_dwordx4 v[92:95], v7, s[20:23], s30 offen offset:0 sc1
    s_waitcnt vmcnt(18)
    ds_read_b64_tr_b16 v[32:33], v10 offset:2048
    ds_read_b64_tr_b16 v[34:35], v10 offset:3072
    ds_read_b64_tr_b16 v[36:37], v11 offset:2048
    ds_read_b64_tr_b16 v[38:39], v11 offset:3072
    s_waitcnt lgkmcnt(6)
    v_mfma_f32_32x32x16_bf16 v[104:119], v[24:27], v[40:43], v[104:119]
    v_mfma_f32_32x32x16_bf16 v[136:151], v[24:27], v[44:47], v[136:151]
    s_waitcnt lgkmcnt(4)
    v_mfma_f32_32x32x16_bf16 v[120:135], v[28:31], v[40:43], v[120:135]
    v_mfma_f32_32x32x16_bf16 v[152:167], v[28:31], v[44:47], v[152:167]
    s_add_u32 s31, s27, 327680
    s_add_u32 m0, s28, 12288
    s_nop 0
    buffer_load_dwordx4 v8, s[8:11], s31 offen lds
    s_add_u32 m0, s28, 13312
    s_nop 0
    buffer_load_dwordx4 v9, s[8:11], s31 offen lds
    buffer_load_dwordx4 v[40:43], v7, s[20:23], s29 offen offset:1024 sc1
    buffer_load_dwordx4 v[44:47], v7, s[20:23], s30 offen offset:1024 sc1
    s_waitcnt vmcnt(18)
    ds_read_b64_tr_b16 v[24:25], v10 offset:4096
    ds_read_b64_tr_b16 v[26:27], v10 offset:5120
    ds_read_b64_tr_b16 v[28:29], v11 offset:4096
    ds_read_b64_tr_b16 v[30:31], v11 offset:5120
    s_waitcnt lgkmcnt(6)
    v_mfma_f32_32x32x16_bf16 v[104:119], v[32:35], v[48:51], v[104:119]
    v_mfma_f32_32x32x16_bf16 v[136:151], v[32:35], v[52:55], v[136:151]
    s_waitcnt lgkmcnt(4)
    v_mfma_f32_32x32x16_bf16 v[120:135], v[36:39], v[48:51], v[120:135]
    v_mfma_f32_32x32x16_bf16 v[152:167], v[36:39], v[52:55], v[152:167]
    s_add_u32 s31, s27, 344064
    s_add_u32 m0, s28, 0
    s_nop 0
    buffer_load_dwordx4 v8, s[8:11], s31 offen lds
    s_add_u32 m0, s28, 1024
    s_nop 0
    buffer_load_dwordx4 v9, s[8:11], s31 offen lds
    buffer_load_dwordx4 v[48:51], v7, s[20:23], s29 offen offset:2048 sc1
    buffer_load_dwordx4 v[52:55], v7, s[20:23], s30 offen offset:2048 sc1
    s_waitcnt vmcnt(18)
    ds_read_b64_tr_b16 v[32:33], v10 offset:6144
    ds_read_b64_tr_b16 v[34:35], v10 offset:7168
    ds_read_b64_tr_b16 v[36:37], v11 offset:6144
    ds_read_b64_tr_b16 v[38:39], v11 offset:7168
    s_waitcnt lgkmcnt(6)
    v_mfma_f32_32x32x16_bf16 v[104:119], v[24:27], v[56:59], v[104:119]
    v_mfma_f32_32x32x16_bf16 v[136:151], v[24:27], v[60:63], v[136:151]
    s_waitcnt lgkmcnt(4)
    v_mfma_f32_32x32x16_bf16 v[120:135], v[28:31], v[56:59], v[120:135]
    v_mfma_f32_32x32x16_bf16 v[152:167], v[28:31], v[60:63], v[152:167]
    s_add_u32 s31, s27, 360448
    s_add_u32 m0, s28, 2048
    s_nop 0
    buffer_load_dwordx4 v8, s[8:11], s31 offen lds
    s_add_u32 m0, s28, 3072
    s_nop 0
    buffer_load_dwordx4 v9, s[8:11], s31 offen lds
    buffer_load_dwordx4 v[56:59], v7, s[20:23], s29 offen offset:3072 sc1
    buffer_load_dwordx4 v[60:63], v7, s[20:23], s30 offen offset:3072 sc1
    s_waitcnt vmcnt(18)
    ds_read_b64_tr_b16 v[24:25], v10 offset:8192
    ds_read_b64_tr_b16 v[26:27], v10 offset:9216
    ds_read_b64_tr_b16 v[28:29], v11 offset:8192
    ds_read_b64_tr_b16 v[30:31], v11 offset:9216
    s_waitcnt lgkmcnt(6)
    v_mfma_f32_32x32x16_bf16 v[104:119], v[32:35], v[64:67], v[104:119]
    v_mfma_f32_32x32x16_bf16 v[136:151], v[32:35], v[68:71], v[136:151]
    s_waitcnt lgkmcnt(4)
    v_mfma_f32_32x32x16_bf16 v[120:135], v[36:39], v[64:67], v[120:135]
    v_mfma_f32_32x32x16_bf16 v[152:167], v[36:39], v[68:71], v[152:167]
    s_add_u32 s31, s27, 376832
    s_add_u32 m0, s28, 4096
    s_nop 0
    buffer_load_dwordx4 v8, s[8:11], s31 offen lds
    s_add_u32 m0, s28, 5120
    s_nop 0
    buffer_load_dwordx4 v9, s[8:11], s31 offen lds
    s_add_u32 s29, s29, 4096
    s_add_u32 s30, s30, 4096
    buffer_load_dwordx4 v[64:67], v7, s[20:23], s29 offen offset:0 sc1
    buffer_load_dwordx4 v[68:71], v7, s[20:23], s30 offen offset:0 sc1
    s_waitcnt vmcnt(18)
    ds_read_b64_tr_b16 v[32:33], v10 offset:10240
    ds_read_b64_tr_b16 v[34:35], v10 offset:11264
    ds_read_b64_tr_b16 v[36:37], v11 offset:10240
    ds_read_b64_tr_b16 v[38:39], v11 offset:11264
    s_waitcnt lgkmcnt(6)
    v_mfma_f32_32x32x16_bf16 v[104:119], v[24:27], v[72:75], v[104:119]
    v_mfma_f32_32x32x16_bf16 v[136:151], v[24:27], v[76:79], v[136:151]
    s_waitcnt lgkmcnt(4)
    v_mfma_f32_32x32x16_bf16 v[120:135], v[28:31], v[72:75], v[120:135]
    v_mfma_f32_32x32x16_bf16 v[152:167], v[28:31], v[76:79], v[152:167]
    s_add_u32 s31, s27, 393216
    s_add_u32 m0, s28, 6144
    s_nop 0
    buffer_load_dwordx4 v8, s[8:11], s31 offen lds
    s_add_u32 m0, s28, 7168
    s_nop 0
    buffer_load_dwordx4 v9, s[8:11], s31 offen lds
    buffer_load_dwordx4 v[72:75], v7, s[20:23], s29 offen offset:1024 sc1
    buffer_load_dwordx4 v[76:79], v7, s[20:23], s30 offen offset:1024 sc1
    s_waitcnt vmcnt(18)
    ds_read_b64_tr_b16 v[24:25], v10 offset:12288
    ds_read_b64_tr_b16 v[26:27], v10 offset:13312
    ds_read_b64_tr_b16 v[28:29], v11 offset:12288
    ds_read_b64_tr_b16 v[30:31], v11 offset:13312
    s_waitcnt lgkmcnt(6)
    v_mfma_f32_32x32x16_bf16 v[104:119], v[32:35], v[80:83], v[104:119]
    v_mfma_f32_32x32x16_bf16 v[136:151], v[32:35], v[84:87], v[136:151]
    s_waitcnt lgkmcnt(4)
    v_mfma_f32_32x32x16_bf16 v[120:135], v[36:39], v[80:83], v[120:135]
    v_mfma_f32_32x32x16_bf16 v[152:167], v[36:39], v[84:87], v[152:167]
    s_add_u32 s31, s27, 409600
    s_add_u32 m0, s28, 8192
    s_nop 0
    buffer_load_dwordx4 v8, s[8:11], s31 offen lds
    s_add_u32 m0, s28, 9216
    s_nop 0
    buffer_load_dwordx4 v9, s[8:11], s31 offen lds
    buffer_load_dwordx4 v[80:83], v7, s[20:23], s29 offen offset:2048 sc1
    buffer_load_dwordx4 v[84:87], v7, s[20:23], s30 offen offset:2048 sc1
    s_waitcnt vmcnt(18)
    ds_read_b64_tr_b16 v[32:33], v10 offset:0
    ds_read_b64_tr_b16 v[34:35], v10 offset:1024
    ds_read_b64_tr_b16 v[36:37], v11 offset:0
    ds_read_b64_tr_b16 v[38:39], v11 offset:1024
    s_waitcnt lgkmcnt(6)
    v_mfma_f32_32x32x16_bf16 v[104:119], v[24:27], v[88:91], v[104:119]
    v_mfma_f32_32x32x16_bf16 v[136:151], v[24:27], v[92:95], v[136:151]
    s_waitcnt lgkmcnt(4)
    v_mfma_f32_32x32x16_bf16 v[120:135], v[28:31], v[88:91], v[120:135]
    v_mfma_f32_32x32x16_bf16 v[152:167], v[28:31], v[92:95], v[152:167]
    s_add_u32 s31, s27, 425984
    s_add_u32 m0, s28, 10240
    s_nop 0
    buffer_load_dwordx4 v8, s[8:11], s31 offen lds
    s_add_u32 m0, s28, 11264
    s_nop 0
    buffer_load_dwordx4 v9, s[8:11], s31 offen lds
    buffer_load_dwordx4 v[88:91], v7, s[20:23], s29 offen offset:3072 sc1
    buffer_load_dwordx4 v[92:95], v7, s[20:23], s30 offen offset:3072 sc1
    s_waitcnt vmcnt(18)
    ds_read_b64_tr_b16 v[24:25], v10 offset:2048
    ds_read_b64_tr_b16 v[26:27], v10 offset:3072
    ds_read_b64_tr_b16 v[28:29], v11 offset:2048
    ds_read_b64_tr_b16 v[30:31], v11 offset:3072
    s_waitcnt lgkmcnt(6)
    v_mfma_f32_32x32x16_bf16 v[104:119], v[32:35], v[40:43], v[104:119]
    v_mfma_f32_32x32x16_bf16 v[136:151], v[32:35], v[44:47], v[136:151]
    s_waitcnt lgkmcnt(4)
    v_mfma_f32_32x32x16_bf16 v[120:135], v[36:39], v[40:43], v[120:135]
    v_mfma_f32_32x32x16_bf16 v[152:167], v[36:39], v[44:47], v[152:167]
    s_add_u32 s31, s27, 442368
    s_add_u32 m0, s28, 12288
    s_nop 0
    buffer_load_dwordx4 v8, s[8:11], s31 offen lds
    s_add_u32 m0, s28, 13312
    s_nop 0
    buffer_load_dwordx4 v9, s[8:11], s31 offen lds
    s_waitcnt vmcnt(16)
    ds_read_b64_tr_b16 v[32:33], v10 offset:4096
    ds_read_b64_tr_b16 v[34:35], v10 offset:5120
    ds_read_b64_tr_b16 v[36:37], v11 offset:4096
    ds_read_b64_tr_b16 v[38:39], v11 offset:5120
    s_waitcnt lgkmcnt(6)
    v_mfma_f32_32x32x16_bf16 v[104:119], v[24:27], v[48:51], v[104:119]
    v_mfma_f32_32x32x16_bf16 v[136:151], v[24:27], v[52:55], v[136:151]
    s_waitcnt lgkmcnt(4)
    v_mfma_f32_32x32x16_bf16 v[120:135], v[28:31], v[48:51], v[120:135]
    v_mfma_f32_32x32x16_bf16 v[152:167], v[28:31], v[52:55], v[152:167]
    s_waitcnt vmcnt(12)
    ds_read_b64_tr_b16 v[24:25], v10 offset:6144
    ds_read_b64_tr_b16 v[26:27], v10 offset:7168
    ds_read_b64_tr_b16 v[28:29], v11 offset:6144
    ds_read_b64_tr_b16 v[30:31], v11 offset:7168
    s_waitcnt lgkmcnt(6)
    v_mfma_f32_32x32x16_bf16 v[104:119], v[32:35], v[56:59], v[104:119]
    v_mfma_f32_32x32x16_bf16 v[136:151], v[32:35], v[60:63], v[136:151]
    s_waitcnt lgkmcnt(4)
    v_mfma_f32_32x32x16_bf16 v[120:135], v[36:39], v[56:59], v[120:135]
    v_mfma_f32_32x32x16_bf16 v[152:167], v[36:39], v[60:63], v[152:167]
    s_waitcnt vmcnt(8)
    ds_read_b64_tr_b16 v[32:33], v10 offset:8192
    ds_read_b64_tr_b16 v[34:35], v10 offset:9216
    ds_read_b64_tr_b16 v[36:37], v11 offset:8192
    ds_read_b64_tr_b16 v[38:39], v11 offset:9216
    s_waitcnt lgkmcnt(6)
    v_mfma_f32_32x32x16_bf16 v[104:119], v[24:27], v[64:67], v[104:119]
    v_mfma_f32_32x32x16_bf16 v[136:151], v[24:27], v[68:71], v[136:151]
    s_waitcnt lgkmcnt(4)
    v_mfma_f32_32x32x16_bf16 v[120:135], v[28:31], v[64:67], v[120:135]
    v_mfma_f32_32x32x16_bf16 v[152:167], v[28:31], v[68:71], v[152:167]
    s_waitcnt vmcnt(4)
    ds_read_b64_tr_b16 v[24:25], v10 offset:10240
    ds_read_b64_tr_b16 v[26:27], v10 offset:11264
    ds_read_b64_tr_b16 v[28:29], v11 offset:10240
    ds_read_b64_tr_b16 v[30:31], v11 offset:11264
    s_waitcnt lgkmcnt(6)
    v_mfma_f32_32x32x16_bf16 v[104:119], v[32:35], v[72:75], v[104:119]
    v_mfma_f32_32x32x16_bf16 v[136:151], v[32:35], v[76:79], v[136:151]
    s_waitcnt lgkmcnt(4)
    v_mfma_f32_32x32x16_bf16 v[120:135], v[36:39], v[72:75], v[120:135]
    v_mfma_f32_32x32x16_bf16 v[152:167], v[36:39], v[76:79], v[152:167]
    s_waitcnt vmcnt(0)
    ds_read_b64_tr_b16 v[32:33], v10 offset:12288
    ds_read_b64_tr_b16 v[34:35], v10 offset:13312
    ds_read_b64_tr_b16 v[36:37], v11 offset:12288
    ds_read_b64_tr_b16 v[38:39], v11 offset:13312
    s_waitcnt lgkmcnt(6)
    v_mfma_f32_32x32x16_bf16 v[104:119], v[24:27], v[80:83], v[104:119]
    v_mfma_f32_32x32x16_bf16 v[136:151], v[24:27], v[84:87], v[136:151]
    s_waitcnt lgkmcnt(4)
    v_mfma_f32_32x32x16_bf16 v[120:135], v[28:31], v[80:83], v[120:135]
    v_mfma_f32_32x32x16_bf16 v[152:167], v[28:31], v[84:87], v[152:167]
    s_waitcnt lgkmcnt(2)
    v_mfma_f32_32x32x16_bf16 v[104:119], v[32:35], v[88:91], v[104:119]
    v_mfma_f32_32x32x16_bf16 v[136:151], v[32:35], v[92:95], v[136:151]
    s_waitcnt lgkmcnt(0)
    v_mfma_f32_32x32x16_bf16 v[120:135], v[36:39], v[88:91], v[120:135]
    v_mfma_f32_32x32x16_bf16 v[152:167], v[36:39], v[92:95], v[152:167]
    s_setprio 2
    v_and_b32 v14, 31, v0
    v_mul_u32_u24 v14, 272, v14
    v_lshrrev_b32 v2, 5, v0
    v_lshl_add_u32 v14, v2, 4, v14
    s_mul_i32 s33, s3, 17408
    s_add_u32 s33, s33, 256
    v_add_u32 v14, s33, v14
    s_nop 5
    ds_write_b128 v14, v[104:107] offset:0
    ds_write_b128 v14, v[108:111] offset:32
    ds_write_b128 v14, v[112:115] offset:64
    ds_write_b128 v14, v[116:119] offset:96
    ds_write_b128 v14, v[120:123] offset:128
    ds_write_b128 v14, v[124:127] offset:160
    ds_write_b128 v14, v[128:131] offset:192
    ds_write_b128 v14, v[132:135] offset:224
    ds_write_b128 v14, v[136:139] offset:8704
    ds_write_b128 v14, v[140:143] offset:8736
    ds_write_b128 v14, v[144:147] offset:8768
    ds_write_b128 v14, v[148:151] offset:8800
    ds_write_b128 v14, v[152:155] offset:8832
    ds_write_b128 v14, v[156:159] offset:8864
    ds_write_b128 v14, v[160:163] offset:8896
    s_waitcnt lgkmcnt(9)
    ds_write_b128 v14, v[164:167] offset:8928
    s_waitcnt lgkmcnt(0)
    s_waitcnt vmcnt(0) lgkmcnt(0)
    v_mov_b32 v1, 0
    v_mov_b32 v2, 1
    s_mov_b64 exec, 1
    ds_add_u32 v1, v2 offset:16
    s_mov_b64 exec, -1
    s_add_u32 s3, s3, 8
F_end:
    s_endpgm
.section .rodata,"a"
.p2align 6
.amdhsa_kernel recurrent_scan__mha_block__glu_gated_glu__prompt_kernel
  .amdhsa_next_free_vgpr 168
  .amdhsa_next_free_sgpr 102
  .amdhsa_accum_offset 168
  .amdhsa_group_segment_fixed_size 0
  .amdhsa_kernarg_size 80
  .amdhsa_user_sgpr_count 2
  .amdhsa_user_sgpr_kernarg_segment_ptr 1
  .amdhsa_system_sgpr_workgroup_id_x 1
.end_amdhsa_kernel
```
